```python
import torch

def _softmax(x, axis=-1):
    return torch.softmax(x, dim=axis)

def _gelu(x):
    return torch.nn.functional.gelu(x, approximate='tanh')

def _silu(x):
    return torch.nn.functional.silu(x)

def _sigmoid(x):
    return torch.sigmoid(x)

def _layernorm(x, axis=-1, eps=1e-05):
    m = x.mean(dim=axis, keepdim=True)
    v = x.var(dim=axis, keepdim=True, unbiased=False)
    return (x - m) / torch.sqrt(v + eps)

def _scatter_add(tgt, idx, src, axis=0):
    return tgt.clone().index_add_(axis, idx, src)

def _segment_sum(src, seg, n):
    out = torch.zeros((n,) + src.shape[1:], dtype=src.dtype)
    return out.index_add_(0, seg, src)

def _pad(x, pw):
    flat = tuple((v for pair in reversed(pw) for v in pair))
    return torch.nn.functional.pad(x, flat)
kernel_name = 'standalone__dilated_atrous__vision'

def setup_inputs():

    _w = lambda a: (lambda t: t.to(torch.bfloat16) if t.is_floating_point() else t)(torch.as_tensor(a))
    H = W = 384
    C = 96
    k = 3
    return {'x': _w((lambda *s: torch.randn(*s, dtype=torch.bfloat16) * 0.05)(1, H, W, C)), 'w': _w((lambda *s: torch.randn(*s, dtype=torch.bfloat16) * 0.05)(k, k, C, C) * (1.0 / (k * C ** 0.5)))}

def reference(x, w):
    B, H, W, C = x.shape
    k = 3
    rate = 2
    pad = (k - 1) * rate // 2
    xp = _pad(x, ((0, 0), (pad, pad), (pad, pad), (0, 0)))
    out = torch.zeros_like(x)
    for i in range(k):
        for j in range(k):
            tap = xp[:, i * rate:i * rate + H, j * rate:j * rate + W, :].clone()
            out = out + torch.einsum('bhwc,co->bhwo', tap, w[i, j])
    return out
```

```asm
; @launch grid=(256,1,1) block=(256,1,1) lds=163840
.amdgcn_target "amdgcn-amd-amdhsa--gfx950"
.text
.globl standalone__dilated_atrous__vision_kernel
.p2align 8
.type standalone__dilated_atrous__vision_kernel,@function
standalone__dilated_atrous__vision_kernel:
    s_cmp_ge_u32 s2, 256
    s_cbranch_scc1 L_end
    s_load_dwordx4 s[4:7], s[0:1], 0
    s_load_dwordx2 s[36:37], s[0:1], 16
    s_getpc_b64 s[54:55]
L_pc:
    v_lshlrev_b32 v10, 7, v0
    v_min_u32 v10, (L_end - L_pc), v10
    v_mov_b32 v11, s55
    v_add_co_u32 v10, vcc, s54, v10
    v_addc_co_u32 v11, vcc, 0, v11, vcc
    global_load_dword v63, v[10:11], off
    v_lshrrev_b32 v1, 6, v0
    v_and_b32 v2, 63, v0
    s_and_b32 s23, s2, 7
    v_readfirstlane_b32 s20, v1
    s_lshr_b32 s26, s2, 3
    s_and_b32 s24, s26, 1
    s_lshr_b32 s25, s26, 1
    s_mul_i32 s34, s23, 48
    s_and_b32 s21, s20, 1
    s_lshr_b32 s22, s20, 1
    s_mul_i32 s27, s21, 320
    v_add_u32 v3, s27, v2
    v_mov_b32 v9, v0
    v_bfrev_b32 v8, 1
    s_mul_i32 s26, s25, 24
    s_add_u32 s26, s26, s24
    s_mul_i32 s27, s22, 12
    s_add_u32 s26, s26, s27
    s_sub_u32 s26, s26, 2
    s_mul_i32 s26, s26, 384
    s_add_u32 s26, s26, s34
    s_sub_u32 s26, s26, 2
    s_mul_i32 s42, s26, 192
    s_cmp_eq_u32 s23, 0
    s_cselect_b32 s38, 2, 0
    s_cmp_eq_u32 s23, 7
    s_cselect_b32 s39, 50, 52
    s_sub_u32 s39, s39, s38
    s_mul_i32 s32, s20, 5120
    s_lshl_b32 s33, s20, 10
    v_mul_u32_u24 v10, 43691, v9
    v_lshrrev_b32 v10, 19, v10
    v_mul_u32_u24 v11, 12, v10
    v_sub_u32 v11, v9, v11
    v_lshrrev_b32 v12, 2, v10
    v_and_b32 v12, 2, v12
    v_sub_u32 v11, v11, v12
    v_add_u32 v12, 12, v11
    v_cmp_gt_i32 vcc, 0, v11
    v_mul_u32_u24 v13, 192, v10
    v_cndmask_b32 v11, v11, v12, vcc
    v_lshl_add_u32 v21, v11, 4, v13
    v_mul_u32_u24 v4, 43691, v3
    v_lshrrev_b32 v4, 19, v4
    v_mul_u32_u24 v5, 12, v4
    v_sub_u32 v5, v3, v5
    v_lshrrev_b32 v6, 1, v4
    v_and_b32 v6, 2, v6
    v_xor_b32 v5, v5, v6
    v_mul_u32_u24 v7, 192, v4
    v_subrev_u32 v6, s38, v4
    v_lshl_add_u32 v7, v5, 4, v7
    v_cmp_gt_u32 vcc, s39, v6
    v_add_u32 v7, s42, v7
    v_cndmask_b32 v16, v8, v7, vcc
    s_mov_b32 s10, 28311552
    s_mov_b32 s11, 0x20000
    s_mov_b32 s14, 165888
    s_mov_b32 s15, 0x20000
    s_waitcnt lgkmcnt(0)
    s_mov_b32 s8, s4
    s_and_b32 s9, s5, 0xffff
    s_mov_b32 s12, s6
    s_and_b32 s13, s7, 0xffff
    s_add_u32 m0, s32, 55296
    s_nop 0
    buffer_load_dwordx4 v16, s[8:11], 0 offen nt lds
    v_add_u32 v16, 147456, v16
    s_add_u32 m0, s33, 0
    s_nop 0
    buffer_load_dwordx4 v21, s[12:15], 0 offen lds
    v_add_u32 v21, 0x3000, v21
    s_add_u32 m0, s32, 56320
    v_add_u32 v3, 64, v3
    v_mul_u32_u24 v4, 43691, v3
    v_lshrrev_b32 v4, 19, v4
    v_mul_u32_u24 v5, 12, v4
    v_sub_u32 v5, v3, v5
    v_lshrrev_b32 v6, 1, v4
    v_and_b32 v6, 2, v6
    v_xor_b32 v5, v5, v6
    v_mul_u32_u24 v7, 192, v4
    v_subrev_u32 v6, s38, v4
    v_lshl_add_u32 v7, v5, 4, v7
    v_cmp_gt_u32 vcc, s39, v6
    v_add_u32 v7, s42, v7
    v_cndmask_b32 v17, v8, v7, vcc
    buffer_load_dwordx4 v17, s[8:11], 0 offen nt lds
    v_add_u32 v17, 147456, v17
    s_add_u32 m0, s33, 4096
    v_add_u32 v9, 0x100, v9
    v_mul_u32_u24 v10, 43691, v9
    v_lshrrev_b32 v10, 19, v10
    v_mul_u32_u24 v11, 12, v10
    v_sub_u32 v11, v9, v11
    v_lshrrev_b32 v12, 2, v10
    v_and_b32 v12, 2, v12
    v_sub_u32 v11, v11, v12
    v_add_u32 v12, 12, v11
    v_cmp_gt_i32 vcc, 0, v11
    v_mul_u32_u24 v13, 192, v10
    v_cndmask_b32 v11, v11, v12, vcc
    v_lshl_add_u32 v22, v11, 4, v13
    buffer_load_dwordx4 v22, s[12:15], 0 offen lds
    v_add_u32 v22, 0x3000, v22
    s_add_u32 m0, s32, 57344
    v_add_u32 v3, 64, v3
    v_mul_u32_u24 v4, 43691, v3
    v_lshrrev_b32 v4, 19, v4
    v_mul_u32_u24 v5, 12, v4
    v_sub_u32 v5, v3, v5
    v_lshrrev_b32 v6, 1, v4
    v_and_b32 v6, 2, v6
    v_xor_b32 v5, v5, v6
    v_mul_u32_u24 v7, 192, v4
    v_subrev_u32 v6, s38, v4
    v_lshl_add_u32 v7, v5, 4, v7
    v_cmp_gt_u32 vcc, s39, v6
    v_add_u32 v7, s42, v7
    v_cndmask_b32 v18, v8, v7, vcc
    buffer_load_dwordx4 v18, s[8:11], 0 offen nt lds
    v_add_u32 v18, 147456, v18
    s_add_u32 m0, s33, 8192
    v_add_u32 v9, 0x100, v9
    v_mul_u32_u24 v10, 43691, v9
    v_lshrrev_b32 v10, 19, v10
    v_mul_u32_u24 v11, 12, v10
    v_sub_u32 v11, v9, v11
    v_lshrrev_b32 v12, 2, v10
    v_and_b32 v12, 2, v12
    v_sub_u32 v11, v11, v12
    v_add_u32 v12, 12, v11
    v_cmp_gt_i32 vcc, 0, v11
    v_mul_u32_u24 v13, 192, v10
    v_cndmask_b32 v11, v11, v12, vcc
    v_lshl_add_u32 v23, v11, 4, v13
    buffer_load_dwordx4 v23, s[12:15], 0 offen lds
    v_add_u32 v23, 0x3000, v23
    s_add_u32 m0, s32, 58368
    v_add_u32 v3, 64, v3
    v_mul_u32_u24 v4, 43691, v3
    v_lshrrev_b32 v4, 19, v4
    v_mul_u32_u24 v5, 12, v4
    v_sub_u32 v5, v3, v5
    v_lshrrev_b32 v6, 1, v4
    v_and_b32 v6, 2, v6
    v_xor_b32 v5, v5, v6
    v_mul_u32_u24 v7, 192, v4
    v_subrev_u32 v6, s38, v4
    v_lshl_add_u32 v7, v5, 4, v7
    v_cmp_gt_u32 vcc, s39, v6
    v_add_u32 v7, s42, v7
    v_cndmask_b32 v19, v8, v7, vcc
    buffer_load_dwordx4 v19, s[8:11], 0 offen nt lds
    v_add_u32 v19, 147456, v19
    s_add_u32 m0, s33, 12288
    v_add_u32 v3, 64, v3
    v_mul_u32_u24 v4, 43691, v3
    v_lshrrev_b32 v4, 19, v4
    v_mul_u32_u24 v5, 12, v4
    v_sub_u32 v5, v3, v5
    v_lshrrev_b32 v6, 1, v4
    v_and_b32 v6, 2, v6
    v_xor_b32 v5, v5, v6
    buffer_load_dwordx4 v21, s[12:15], 0 offen lds
    v_add_u32 v21, 0x3000, v21
    s_add_u32 m0, s32, 59392
    v_mul_u32_u24 v7, 192, v4
    v_subrev_u32 v6, s38, v4
    v_lshl_add_u32 v7, v5, 4, v7
    v_cmp_gt_u32 vcc, s39, v6
    v_add_u32 v7, s42, v7
    v_cndmask_b32 v20, v8, v7, vcc
    s_add_u32 s35, s33, 53248
    s_add_u32 s43, s33, 159744
    buffer_load_dwordx4 v20, s[8:11], 0 offen nt lds
    v_add_u32 v20, 147456, v20
    s_add_u32 m0, s33, 16384
    s_cmp_ge_u32 s20, 2
    s_cselect_b32 s35, 161792, s35
    s_cselect_b32 s43, 161792, s43
    v_lshrrev_b32 v3, 4, v2
    v_lshrrev_b32 v4, 2, v2
    v_and_b32 v4, 3, v4
    v_lshl_add_u32 v4, v3, 3, v4
    v_mul_u32_u24 v4, 192, v4
    v_and_b32 v5, 3, v2
    v_mul_u32_u24 v5, 24, v5
    buffer_load_dwordx4 v22, s[12:15], 0 offen lds
    v_add_u32 v22, 0x3000, v22
    s_add_u32 m0, s33, 20480
    s_mul_i32 s28, s21, 96
    v_add_u32 v5, s28, v5
    v_and_b32 v6, 1, v3
    v_lshlrev_b32 v6, 5, v6
    v_add_u32 v5, v5, v6
    v_add_u32 v6, 0, v5
    v_subrev_u32 v7, 192, v6
    v_cmp_le_u32 vcc, 192, v6
    buffer_load_dwordx4 v23, s[12:15], 0 offen lds
    v_add_u32 v23, 0x3000, v23
    s_add_u32 m0, s33, 24576
    v_cndmask_b32 v6, v6, v7, vcc
    v_add_u32 v24, v4, v6
    v_add_u32 v6, 8, v5
    v_subrev_u32 v7, 192, v6
    v_cmp_le_u32 vcc, 192, v6
    v_cndmask_b32 v6, v6, v7, vcc
    v_add_u32 v25, v4, v6
    v_add_u32 v6, 16, v5
    buffer_load_dwordx4 v21, s[12:15], 0 offen lds
    v_add_u32 v21, 0x3000, v21
    s_add_u32 m0, s33, 28672
    v_subrev_u32 v7, 192, v6
    v_cmp_le_u32 vcc, 192, v6
    v_cndmask_b32 v6, v6, v7, vcc
    v_add_u32 v26, v4, v6
    v_and_b32 v4, 15, v2
    s_mul_i32 s58, s22, 10240
    s_add_u32 s29, s58, 55296
    v_lshrrev_b32 v5, 1, v4
    buffer_load_dwordx4 v22, s[12:15], 0 offen lds
    v_add_u32 v22, 0x3000, v22
    s_add_u32 m0, s33, 32768
    v_and_b32 v6, 1, v4
    v_mul_u32_u24 v5, 6, v5
    v_add_u32 v28, v5, v6
    v_add_u32 v5, 0, v28
    v_lshrrev_b32 v6, 1, v5
    v_and_b32 v6, 2, v6
    v_xor_b32 v6, v6, v3
    v_mul_u32_u24 v5, 192, v5
    buffer_load_dwordx4 v23, s[12:15], 0 offen lds
    v_add_u32 v23, 0x3000, v23
    s_add_u32 m0, s33, 36864
    v_lshl_add_u32 v5, v6, 4, v5
    v_add_u32 v27, s29, v5
    v_add_u32 v5, 2, v28
    v_lshrrev_b32 v6, 1, v5
    v_and_b32 v6, 2, v6
    v_xor_b32 v6, v6, v3
    v_mul_u32_u24 v5, 192, v5
    v_lshl_add_u32 v5, v6, 4, v5
    buffer_load_dwordx4 v21, s[12:15], 0 offen lds
    v_add_u32 v21, 0x3000, v21
    s_add_u32 m0, s33, 40960
    v_add_u32 v29, s29, v5
    v_add_u32 v5, 4, v28
    v_lshrrev_b32 v6, 1, v5
    v_and_b32 v6, 2, v6
    v_xor_b32 v6, v6, v3
    v_mul_u32_u24 v5, 192, v5
    v_lshl_add_u32 v5, v6, 4, v5
    v_add_u32 v0, s29, v5
    buffer_load_dwordx4 v22, s[12:15], 0 offen lds
    v_add_u32 v22, 0x3000, v22
    s_add_u32 m0, s33, 45056
    v_add_u32 v5, 6, v28
    v_lshrrev_b32 v6, 1, v5
    v_and_b32 v6, 2, v6
    v_xor_b32 v6, v6, v3
    v_mul_u32_u24 v5, 192, v5
    v_lshl_add_u32 v5, v6, 4, v5
    v_add_u32 v1, s29, v5
    v_add_u32 v5, 8, v28
    buffer_load_dwordx4 v23, s[12:15], 0 offen lds
    v_add_u32 v23, 0x4800, v23
    s_add_u32 m0, s33, 49152
    v_lshrrev_b32 v6, 1, v5
    v_and_b32 v6, 2, v6
    v_xor_b32 v6, v6, v3
    v_mul_u32_u24 v5, 192, v5
    v_lshl_add_u32 v5, v6, 4, v5
    v_add_u32 v37, s29, v5
    s_mov_b32 s56, 0x04286031
    s_mov_b32 s57, 0x602860
    buffer_load_dwordx4 v21, s[12:15], 0 offen lds
    v_add_u32 v21, 0x1800, v21
    s_mov_b32 m0, s35
    s_mov_b32 s40, 294912
    s_cmp_eq_u32 s22, 0
    s_cselect_b32 s56, 0x31975420, s56
    s_cselect_b32 s57, 0x549754, s57
    s_cselect_b32 s40, 1032192, s40
    s_mul_i32 s30, s21, 5120
    s_add_u32 s30, s30, 55296
    s_mov_b32 s31, 147456
    v_add_u32 v13, 106496, v24
    v_add_u32 v14, 106496, v25
    v_add_u32 v15, 106496, v26
    buffer_load_dwordx4 v22, s[12:15], 0 offen lds
    v_add_u32 v22, 0x1800, v22
    s_add_u32 m0, s32, 75776
    s_mov_b32 s16, s36
    s_and_b32 s17, s37, 0xffff
    s_mov_b32 s18, 0
    s_mov_b32 s19, 0x20000
    s_mov_b32 s59, 20480
    s_mov_b32 s61, 2
    s_mul_i32 s29, s22, 9984
    s_add_u32 s28, s28, s29
    buffer_load_dwordx4 v16, s[8:11], 0 offen nt lds
    v_add_u32 v16, 147456, v16
    s_add_u32 m0, s32, 76800
    v_mul_u32_u24 v5, 208, v28
    v_mul_u32_u24 v6, 24, v3
    v_add3_u32 v30, v5, v6, s28
    s_mul_i32 s28, s21, 320
    v_add_u32 v5, s28, v2
    v_mul_u32_u24 v6, 43691, v5
    v_lshrrev_b32 v6, 19, v6
    v_mul_u32_u24 v7, 12, v6
    buffer_load_dwordx4 v17, s[8:11], 0 offen nt lds
    v_add_u32 v17, 147456, v17
    s_add_u32 m0, s32, 77824
    v_sub_u32 v7, v5, v7
    v_mul_u32_u24 v6, 208, v6
    v_lshl_add_u32 v6, v7, 4, v6
    v_add_u32 v31, s29, v6
    v_add_u32 v5, 64, v5
    v_mul_u32_u24 v6, 43691, v5
    v_lshrrev_b32 v6, 19, v6
    v_mul_u32_u24 v7, 12, v6
    buffer_load_dwordx4 v18, s[8:11], 0 offen nt lds
    v_add_u32 v18, 147456, v18
    s_add_u32 m0, s32, 78848
    v_sub_u32 v7, v5, v7
    v_mul_u32_u24 v6, 208, v6
    v_lshl_add_u32 v6, v7, 4, v6
    v_add_u32 v32, s29, v6
    v_add_u32 v5, 64, v5
    v_mul_u32_u24 v6, 43691, v5
    v_lshrrev_b32 v6, 19, v6
    v_mul_u32_u24 v7, 12, v6
    buffer_load_dwordx4 v19, s[8:11], 0 offen nt lds
    v_add_u32 v19, 147456, v19
    s_add_u32 m0, s32, 79872
    v_sub_u32 v7, v5, v7
    v_mul_u32_u24 v6, 208, v6
    v_lshl_add_u32 v6, v7, 4, v6
    v_add_u32 v33, s29, v6
    v_add_u32 v5, 64, v5
    v_mul_u32_u24 v6, 43691, v5
    v_lshrrev_b32 v6, 19, v6
    v_mul_u32_u24 v7, 12, v6
    buffer_load_dwordx4 v20, s[8:11], 0 offen nt lds
    v_add_u32 v20, 147456, v20
    s_waitcnt vmcnt(14)
    s_barrier
    s_lshr_b32 s56, s56, 4
    s_and_b32 s62, s56, 15
    s_mul_i32 s62, s62, 10240
    s_sub_u32 s63, s62, s58
    s_mov_b32 s58, s62
    ds_read_b64_tr_b16 a[0:1], v24 offset:0
    ds_read_b64_tr_b16 a[2:3], v24 offset:768
    ds_read_b64_tr_b16 a[4:5], v25 offset:0
    ds_read_b64_tr_b16 a[6:7], v25 offset:768
    ds_read_b64_tr_b16 a[8:9], v26 offset:0
    ds_read_b64_tr_b16 a[10:11], v26 offset:768
    ds_read_b128 v[44:47], v27 offset:0
    ds_read_b128 v[56:59], v29 offset:0
    ds_read_b128 v[68:71], v0 offset:0
    ds_read_b128 v[48:51], v27 offset:64
    ds_read_b64_tr_b16 a[12:13], v24 offset:6144
    ds_read_b64_tr_b16 a[14:15], v24 offset:6912
    ds_read_b64_tr_b16 a[16:17], v25 offset:6144
    ds_read_b64_tr_b16 a[18:19], v25 offset:6912
    ds_read_b64_tr_b16 a[20:21], v26 offset:6144
    ds_read_b64_tr_b16 a[22:23], v26 offset:6912
    ds_read_b128 v[60:63], v29 offset:64
    s_waitcnt lgkmcnt(10)
    v_mfma_f32_16x16x32_bf16 v[80:83], a[0:3], v[44:47], 0
    s_add_u32 m0, s33, 106496
    v_mfma_f32_16x16x32_bf16 v[84:87], a[4:7], v[44:47], 0
    buffer_load_dwordx4 v21, s[12:15], 0 offen lds
    v_mfma_f32_16x16x32_bf16 v[88:91], a[8:11], v[44:47], 0
    v_add_u32 v21, 0x3000, v21
    ds_read_b128 v[72:75], v0 offset:64
    s_waitcnt lgkmcnt(10)
    v_mfma_f32_16x16x32_bf16 v[92:95], a[0:3], v[56:59], 0
    s_add_u32 m0, s33, 110592
    v_mfma_f32_16x16x32_bf16 v[96:99], a[4:7], v[56:59], 0
    buffer_load_dwordx4 v22, s[12:15], 0 offen lds
    v_mfma_f32_16x16x32_bf16 v[100:103], a[8:11], v[56:59], 0
    v_add_u32 v22, 0x3000, v22
    ds_read_b128 v[52:55], v27 offset:128
    v_add_u32 v27, s63, v27
    s_waitcnt lgkmcnt(10)
    v_mfma_f32_16x16x32_bf16 v[104:107], a[0:3], v[68:71], 0
    s_add_u32 m0, s33, 114688
    s_nop 0
    buffer_load_dwordx4 v23, s[12:15], 0 offen lds
    v_mfma_f32_16x16x32_bf16 v[108:111], a[4:7], v[68:71], 0
    v_add_u32 v23, 0x3000, v23
    v_mfma_f32_16x16x32_bf16 v[112:115], a[8:11], v[68:71], 0
    ds_read_b64_tr_b16 a[24:25], v24 offset:12288
    ds_read_b128 v[64:67], v29 offset:128
    v_add_u32 v29, s63, v29
    s_waitcnt lgkmcnt(5)
    v_mfma_f32_16x16x32_bf16 v[80:83], a[12:15], v[48:51], v[80:83]
    ds_read_b64_tr_b16 a[26:27], v24 offset:13056
    ds_read_b64_tr_b16 a[28:29], v25 offset:12288
    v_mfma_f32_16x16x32_bf16 v[84:87], a[16:19], v[48:51], v[84:87]
    ds_read_b64_tr_b16 a[30:31], v25 offset:13056
    v_mfma_f32_16x16x32_bf16 v[88:91], a[20:23], v[48:51], v[88:91]
    ds_read_b64_tr_b16 a[32:33], v26 offset:12288
    ds_read_b128 v[76:79], v0 offset:128
    v_add_u32 v0, s63, v0
    s_waitcnt lgkmcnt(9)
    v_mfma_f32_16x16x32_bf16 v[92:95], a[12:15], v[60:63], v[92:95]
    ds_read_b64_tr_b16 a[34:35], v26 offset:13056
    v_mfma_f32_16x16x32_bf16 v[96:99], a[16:19], v[60:63], v[96:99]
    s_add_u32 m0, s33, 118784
    v_mfma_f32_16x16x32_bf16 v[100:103], a[20:23], v[60:63], v[100:103]
    buffer_load_dwordx4 v21, s[12:15], 0 offen lds
    v_add_u32 v21, 0x3000, v21
    s_add_u32 m0, s33, 122880
    s_nop 0
    buffer_load_dwordx4 v22, s[12:15], 0 offen lds
    v_add_u32 v22, 0x3000, v22
    s_add_u32 m0, s33, 126976
    s_nop 0
    buffer_load_dwordx4 v23, s[12:15], 0 offen lds
    v_add_u32 v23, 0x3000, v23
    s_waitcnt vmcnt(16)
    s_barrier
    s_waitcnt lgkmcnt(9)
    v_mfma_f32_16x16x32_bf16 v[104:107], a[12:15], v[72:75], v[104:107]
    ds_read_b64_tr_b16 a[36:37], v24 offset:18432
    v_mfma_f32_16x16x32_bf16 v[108:111], a[16:19], v[72:75], v[108:111]
    ds_read_b64_tr_b16 a[38:39], v24 offset:19200
    v_mfma_f32_16x16x32_bf16 v[112:115], a[20:23], v[72:75], v[112:115]
    ds_read_b64_tr_b16 a[40:41], v25 offset:18432
    s_waitcnt lgkmcnt(3)
    v_mfma_f32_16x16x32_bf16 v[80:83], a[24:27], v[52:55], v[80:83]
    ds_read_b64_tr_b16 a[42:43], v25 offset:19200
    v_mfma_f32_16x16x32_bf16 v[84:87], a[28:31], v[52:55], v[84:87]
    ds_read_b64_tr_b16 a[44:45], v26 offset:18432
    v_mfma_f32_16x16x32_bf16 v[88:91], a[32:35], v[52:55], v[88:91]
    ds_read_b64_tr_b16 a[46:47], v26 offset:19200
    ds_read_b128 v[44:47], v1 offset:0
    v_mfma_f32_16x16x32_bf16 v[92:95], a[24:27], v[64:67], v[92:95]
    s_add_u32 m0, s33, 131072
    v_mfma_f32_16x16x32_bf16 v[96:99], a[28:31], v[64:67], v[96:99]
    buffer_load_dwordx4 v21, s[12:15], 0 offen lds
    v_mfma_f32_16x16x32_bf16 v[100:103], a[32:35], v[64:67], v[100:103]
    v_add_u32 v21, 0x3000, v21
    v_mfma_f32_16x16x32_bf16 v[104:107], a[24:27], v[76:79], v[104:107]
    s_add_u32 m0, s33, 135168
    s_nop 0
    buffer_load_dwordx4 v22, s[12:15], 0 offen lds
    v_mfma_f32_16x16x32_bf16 v[108:111], a[28:31], v[76:79], v[108:111]
    v_add_u32 v22, 0x3000, v22
    s_add_u32 m0, s33, 139264
    v_mfma_f32_16x16x32_bf16 v[112:115], a[32:35], v[76:79], v[112:115]
    buffer_load_dwordx4 v23, s[12:15], 0 offen lds
    v_add_u32 v23, 0x3000, v23
    s_waitcnt lgkmcnt(1)
    v_mfma_f32_16x16x32_bf16 v[80:83], a[36:39], v[56:59], v[80:83]
    ds_read_b64_tr_b16 a[48:49], v24 offset:24576
    ds_read_b64_tr_b16 a[50:51], v24 offset:25344
    v_mfma_f32_16x16x32_bf16 v[84:87], a[40:43], v[56:59], v[84:87]
    ds_read_b64_tr_b16 a[52:53], v25 offset:24576
    v_mfma_f32_16x16x32_bf16 v[88:91], a[44:47], v[56:59], v[88:91]
    ds_read_b64_tr_b16 a[54:55], v25 offset:25344
    ds_read_b128 v[48:51], v1 offset:64
    v_mfma_f32_16x16x32_bf16 v[92:95], a[36:39], v[68:71], v[92:95]
    ds_read_b64_tr_b16 a[56:57], v26 offset:24576
    ds_read_b64_tr_b16 a[58:59], v26 offset:25344
    v_mfma_f32_16x16x32_bf16 v[96:99], a[40:43], v[68:71], v[96:99]
    s_add_u32 m0, s33, 143360
    v_mfma_f32_16x16x32_bf16 v[100:103], a[44:47], v[68:71], v[100:103]
    buffer_load_dwordx4 v21, s[12:15], 0 offen lds
    s_waitcnt lgkmcnt(7)
    v_mfma_f32_16x16x32_bf16 v[104:107], a[36:39], v[44:47], v[104:107]
    v_add_u32 v21, 0x3000, v21
    s_add_u32 m0, s33, 147456
    v_mfma_f32_16x16x32_bf16 v[108:111], a[40:43], v[44:47], v[108:111]
    buffer_load_dwordx4 v22, s[12:15], 0 offen lds
    v_add_u32 v22, 0x3000, v22
    v_mfma_f32_16x16x32_bf16 v[112:115], a[44:47], v[44:47], v[112:115]
    s_add_u32 m0, s33, 151552
    s_nop 0
    buffer_load_dwordx4 v23, s[12:15], 0 offen lds
    s_waitcnt lgkmcnt(0)
    v_mfma_f32_16x16x32_bf16 v[80:83], a[48:51], v[60:63], v[80:83]
    v_add_u32 v23, 0x4800, v23
    ds_read_b64_tr_b16 a[60:61], v24 offset:30720
    v_mfma_f32_16x16x32_bf16 v[84:87], a[52:55], v[60:63], v[84:87]
    ds_read_b64_tr_b16 a[62:63], v24 offset:31488
    ds_read_b64_tr_b16 a[64:65], v25 offset:30720
    v_mfma_f32_16x16x32_bf16 v[88:91], a[56:59], v[60:63], v[88:91]
    ds_read_b64_tr_b16 a[66:67], v25 offset:31488
    ds_read_b128 v[52:55], v1 offset:128
    v_add_u32 v1, s63, v1
    v_mfma_f32_16x16x32_bf16 v[92:95], a[48:51], v[72:75], v[92:95]
    ds_read_b64_tr_b16 a[68:69], v26 offset:30720
    ds_read_b64_tr_b16 a[70:71], v26 offset:31488
    v_mfma_f32_16x16x32_bf16 v[96:99], a[52:55], v[72:75], v[96:99]
    s_add_u32 m0, s33, 155648
    v_mfma_f32_16x16x32_bf16 v[100:103], a[56:59], v[72:75], v[100:103]
    buffer_load_dwordx4 v21, s[12:15], 0 offen lds
    v_add_u32 v21, 0x1800, v21
    s_mov_b32 m0, s43
    s_nop 0
    buffer_load_dwordx4 v22, s[12:15], 0 offen lds
    v_add_u32 v22, 0x1800, v22
    v_sub_u32 v7, v5, v7
    v_mul_u32_u24 v6, 208, v6
    v_lshl_add_u32 v6, v7, 4, v6
    v_add_u32 v34, s29, v6
    v_add_u32 v5, 64, v5
    v_mul_u32_u24 v6, 43691, v5
    v_lshrrev_b32 v6, 19, v6
    v_mul_u32_u24 v7, 12, v6
    v_sub_u32 v7, v5, v7
    v_mul_u32_u24 v6, 208, v6
    v_lshl_add_u32 v6, v7, 4, v6
    v_add_u32 v35, s29, v6
    s_lshl_b32 s28, s25, 1
    s_add_u32 s28, s28, s22
    s_mul_i32 s28, s28, 12
    s_sub_u32 s28, s28, 2
    s_add_u32 s28, s28, s24
    s_mul_i32 s28, s28, 384
    s_add_u32 s28, s28, s34
    s_mul_i32 s28, s28, 192
    s_mul_i32 s29, s21, 5120
    s_add_u32 s28, s28, s29
    v_lshlrev_b32 v5, 4, v2
    v_add_u32 v36, s28, v5
    s_add_u32 s84, s36, 4096
    s_addc_u32 s85, s37, 0
    s_and_b32 s85, s85, 0xffff
    s_mov_b32 s86, 0
    s_mov_b32 s87, 0x20000
    s_cmp_eq_u32 s21, 0
    s_cselect_b32 s88, 28307456, 0
    s_waitcnt vmcnt(19)
    s_barrier
    v_mfma_f32_16x16x32_bf16 v[104:107], a[48:51], v[48:51], v[104:107]
    ds_read_b64_tr_b16 a[72:73], v24 offset:36864
    v_mfma_f32_16x16x32_bf16 v[108:111], a[52:55], v[48:51], v[108:111]
    ds_read_b64_tr_b16 a[74:75], v24 offset:37632
    v_mfma_f32_16x16x32_bf16 v[112:115], a[56:59], v[48:51], v[112:115]
    ds_read_b64_tr_b16 a[76:77], v25 offset:36864
    s_waitcnt lgkmcnt(3)
    v_mfma_f32_16x16x32_bf16 v[80:83], a[60:63], v[64:67], v[80:83]
    ds_read_b64_tr_b16 a[78:79], v25 offset:37632
    v_mfma_f32_16x16x32_bf16 v[84:87], a[64:67], v[64:67], v[84:87]
    ds_read_b64_tr_b16 a[80:81], v26 offset:36864
    v_mfma_f32_16x16x32_bf16 v[88:91], a[68:71], v[64:67], v[88:91]
    ds_read_b64_tr_b16 a[82:83], v26 offset:37632
    ds_read_b128 v[56:59], v37 offset:0
    v_mfma_f32_16x16x32_bf16 v[92:95], a[60:63], v[76:79], v[92:95]
    v_mfma_f32_16x16x32_bf16 v[96:99], a[64:67], v[76:79], v[96:99]
    v_mfma_f32_16x16x32_bf16 v[100:103], a[68:71], v[76:79], v[100:103]
    v_mfma_f32_16x16x32_bf16 v[104:107], a[60:63], v[52:55], v[104:107]
    ds_read_b64_tr_b16 a[84:85], v24 offset:43008
    v_mfma_f32_16x16x32_bf16 v[108:111], a[64:67], v[52:55], v[108:111]
    ds_read_b64_tr_b16 a[86:87], v24 offset:43776
    v_mfma_f32_16x16x32_bf16 v[112:115], a[68:71], v[52:55], v[112:115]
    ds_read_b64_tr_b16 a[88:89], v25 offset:43008
    s_waitcnt lgkmcnt(4)
    v_mfma_f32_16x16x32_bf16 v[80:83], a[72:75], v[68:71], v[80:83]
    ds_read_b64_tr_b16 a[90:91], v25 offset:43776
    v_mfma_f32_16x16x32_bf16 v[84:87], a[76:79], v[68:71], v[84:87]
    ds_read_b64_tr_b16 a[92:93], v26 offset:43008
    v_mfma_f32_16x16x32_bf16 v[88:91], a[80:83], v[68:71], v[88:91]
    ds_read_b64_tr_b16 a[94:95], v26 offset:43776
    ds_read_b128 v[60:63], v37 offset:64
    v_mfma_f32_16x16x32_bf16 v[92:95], a[72:75], v[44:47], v[92:95]
    v_mfma_f32_16x16x32_bf16 v[96:99], a[76:79], v[44:47], v[96:99]
    v_mfma_f32_16x16x32_bf16 v[100:103], a[80:83], v[44:47], v[100:103]
    s_waitcnt lgkmcnt(7)
    v_mfma_f32_16x16x32_bf16 v[104:107], a[72:75], v[56:59], v[104:107]
    ds_read_b64_tr_b16 a[96:97], v24 offset:49152
    v_mfma_f32_16x16x32_bf16 v[108:111], a[76:79], v[56:59], v[108:111]
    ds_read_b64_tr_b16 a[98:99], v24 offset:49920
    v_mfma_f32_16x16x32_bf16 v[112:115], a[80:83], v[56:59], v[112:115]
    ds_read_b64_tr_b16 a[100:101], v25 offset:49152
    s_waitcnt lgkmcnt(4)
    v_mfma_f32_16x16x32_bf16 v[80:83], a[84:87], v[72:75], v[80:83]
    ds_read_b64_tr_b16 a[102:103], v25 offset:49920
    v_mfma_f32_16x16x32_bf16 v[84:87], a[88:91], v[72:75], v[84:87]
    ds_read_b64_tr_b16 a[104:105], v26 offset:49152
    v_mfma_f32_16x16x32_bf16 v[88:91], a[92:95], v[72:75], v[88:91]
    ds_read_b64_tr_b16 a[106:107], v26 offset:49920
    ds_read_b128 v[64:67], v37 offset:128
    v_add_u32 v37, s63, v37
    v_mfma_f32_16x16x32_bf16 v[92:95], a[84:87], v[48:51], v[92:95]
    v_mfma_f32_16x16x32_bf16 v[96:99], a[88:91], v[48:51], v[96:99]
    v_mfma_f32_16x16x32_bf16 v[100:103], a[92:95], v[48:51], v[100:103]
    s_lshr_b32 s56, s56, 4
    s_and_b32 s62, s56, 15
    s_mul_i32 s62, s62, 10240
    s_sub_u32 s63, s62, s58
    s_mov_b32 s58, s62
    s_waitcnt lgkmcnt(1)
    s_waitcnt lgkmcnt(0)
    s_waitcnt vmcnt(14)
    s_waitcnt vmcnt(9)
    s_barrier
    ds_read_b128 v[44:47], v27 offset:0
    v_mfma_f32_16x16x32_bf16 v[104:107], a[84:87], v[60:63], v[104:107]
    ds_read_b64_tr_b16 a[108:109], v13 offset:0
    v_mfma_f32_16x16x32_bf16 v[108:111], a[88:91], v[60:63], v[108:111]
    ds_read_b64_tr_b16 a[110:111], v13 offset:768
    v_mfma_f32_16x16x32_bf16 v[112:115], a[92:95], v[60:63], v[112:115]
    ds_read_b64_tr_b16 a[112:113], v14 offset:0
    ds_read_b128 v[56:59], v29 offset:0
    v_mfma_f32_16x16x32_bf16 v[80:83], a[96:99], v[76:79], v[80:83]
    ds_read_b64_tr_b16 a[114:115], v14 offset:768
    ds_read_b64_tr_b16 a[116:117], v15 offset:0
    v_mfma_f32_16x16x32_bf16 v[84:87], a[100:103], v[76:79], v[84:87]
    ds_read_b64_tr_b16 a[118:119], v15 offset:768
    s_and_b32 s41, s57, 15
    v_mfma_f32_16x16x32_bf16 v[88:91], a[104:107], v[76:79], v[88:91]
    s_mul_i32 s41, s41, 10240
    ds_read_b128 v[68:71], v0 offset:0
    v_mfma_f32_16x16x32_bf16 v[92:95], a[96:99], v[52:55], v[92:95]
    s_add_u32 s60, s41, s30
    s_lshr_b32 s57, s57, 4
    v_mfma_f32_16x16x32_bf16 v[96:99], a[100:103], v[52:55], v[96:99]
    s_add_u32 m0, s60, 0
    v_mfma_f32_16x16x32_bf16 v[100:103], a[104:107], v[52:55], v[100:103]
    buffer_load_dwordx4 v16, s[8:11], 0 offen nt lds
    ds_read_b128 v[48:51], v27 offset:64
    v_mfma_f32_16x16x32_bf16 v[104:107], a[96:99], v[64:67], v[104:107]
    v_add_u32 v16, s31, v16
    s_add_u32 m0, s60, 1024
    v_mfma_f32_16x16x32_bf16 v[108:111], a[100:103], v[64:67], v[108:111]
    buffer_load_dwordx4 v17, s[8:11], 0 offen nt lds
    v_add_u32 v17, s31, v17
    v_mfma_f32_16x16x32_bf16 v[112:115], a[104:107], v[64:67], v[112:115]
    s_add_u32 m0, s60, 2048
    s_nop 0
    buffer_load_dwordx4 v18, s[8:11], 0 offen nt lds
    ds_read_b128 v[60:63], v29 offset:64
    s_waitcnt lgkmcnt(3)
    v_mfma_f32_16x16x32_bf16 v[116:119], a[108:111], v[44:47], v[80:83]
    v_add_u32 v18, s31, v18
    ds_read_b64_tr_b16 a[120:121], v13 offset:6144
    v_mfma_f32_16x16x32_bf16 v[120:123], a[112:115], v[44:47], v[84:87]
    ds_read_b64_tr_b16 a[122:123], v13 offset:6912
    ds_read_b64_tr_b16 a[124:125], v14 offset:6144
    v_mfma_f32_16x16x32_bf16 v[124:127], a[116:119], v[44:47], v[88:91]
    ds_read_b64_tr_b16 a[126:127], v14 offset:6912
    v_mfma_f32_16x16x32_bf16 v[80:83], a[0:3], v[44:47], 0
    ds_read_b64_tr_b16 a[128:129], v15 offset:6144
    v_mfma_f32_16x16x32_bf16 v[84:87], a[4:7], v[44:47], 0
    ds_read_b64_tr_b16 a[130:131], v15 offset:6912
    v_mfma_f32_16x16x32_bf16 v[88:91], a[8:11], v[44:47], 0
    ds_read_b128 v[72:75], v0 offset:64
    v_mfma_f32_16x16x32_bf16 v[128:131], a[108:111], v[56:59], v[92:95]
    s_add_u32 m0, s60, 3072
    v_mfma_f32_16x16x32_bf16 v[132:135], a[112:115], v[56:59], v[96:99]
    buffer_load_dwordx4 v19, s[8:11], 0 offen nt lds
    v_mfma_f32_16x16x32_bf16 v[136:139], a[116:119], v[56:59], v[100:103]
    v_add_u32 v19, s31, v19
    v_mfma_f32_16x16x32_bf16 v[92:95], a[0:3], v[56:59], 0
    s_add_u32 m0, s60, 4096
    v_mfma_f32_16x16x32_bf16 v[96:99], a[4:7], v[56:59], 0
    buffer_load_dwordx4 v20, s[8:11], 0 offen nt lds
    v_mfma_f32_16x16x32_bf16 v[100:103], a[8:11], v[56:59], 0
    ds_read_b128 v[52:55], v27 offset:128
    v_add_u32 v27, s63, v27
    s_waitcnt lgkmcnt(10)
    v_mfma_f32_16x16x32_bf16 v[140:143], a[108:111], v[68:71], v[104:107]
    v_add_u32 v20, s31, v20
    s_add_u32 m0, s33, 0
    v_mfma_f32_16x16x32_bf16 v[144:147], a[112:115], v[68:71], v[108:111]
    buffer_load_dwordx4 v21, s[12:15], 0 offen lds
    v_add_u32 v21, 0x3000, v21
    v_mfma_f32_16x16x32_bf16 v[148:151], a[116:119], v[68:71], v[112:115]
    ds_read_b64_tr_b16 a[132:133], v13 offset:12288
    v_mfma_f32_16x16x32_bf16 v[104:107], a[0:3], v[68:71], 0
    ds_read_b64_tr_b16 a[134:135], v13 offset:13056
    v_mfma_f32_16x16x32_bf16 v[108:111], a[4:7], v[68:71], 0
    ds_read_b64_tr_b16 a[136:137], v14 offset:12288
    v_mfma_f32_16x16x32_bf16 v[112:115], a[8:11], v[68:71], 0
    ds_read_b128 v[64:67], v29 offset:128
    v_add_u32 v29, s63, v29
    s_waitcnt lgkmcnt(6)
    v_mfma_f32_16x16x32_bf16 v[116:119], a[120:123], v[48:51], v[116:119]
    ds_read_b64_tr_b16 a[138:139], v14 offset:13056
    v_mfma_f32_16x16x32_bf16 v[120:123], a[124:127], v[48:51], v[120:123]
    ds_read_b64_tr_b16 a[140:141], v15 offset:12288
    v_mfma_f32_16x16x32_bf16 v[124:127], a[128:131], v[48:51], v[124:127]
    ds_read_b64_tr_b16 a[142:143], v15 offset:13056
    v_mfma_f32_16x16x32_bf16 v[80:83], a[12:15], v[48:51], v[80:83]
    s_add_u32 m0, s33, 4096
    v_mfma_f32_16x16x32_bf16 v[84:87], a[16:19], v[48:51], v[84:87]
    buffer_load_dwordx4 v22, s[12:15], 0 offen lds
    v_mfma_f32_16x16x32_bf16 v[88:91], a[20:23], v[48:51], v[88:91]
    ds_read_b128 v[76:79], v0 offset:128
    v_add_u32 v0, s63, v0
    v_mfma_f32_16x16x32_bf16 v[128:131], a[120:123], v[60:63], v[128:131]
    v_add_u32 v22, 0x3000, v22
    v_mfma_f32_16x16x32_bf16 v[132:135], a[124:127], v[60:63], v[132:135]
    s_add_u32 m0, s33, 8192
    v_mfma_f32_16x16x32_bf16 v[136:139], a[128:131], v[60:63], v[136:139]
    buffer_load_dwordx4 v23, s[12:15], 0 offen lds
    v_mfma_f32_16x16x32_bf16 v[92:95], a[12:15], v[60:63], v[92:95]
    v_add_u32 v23, 0x3000, v23
    v_mfma_f32_16x16x32_bf16 v[96:99], a[16:19], v[60:63], v[96:99]
    v_mfma_f32_16x16x32_bf16 v[100:103], a[20:23], v[60:63], v[100:103]
    s_add_u32 m0, s33, 12288
    s_nop 0
    buffer_load_dwordx4 v21, s[12:15], 0 offen lds
    v_add_u32 v21, 0x3000, v21
    s_waitcnt vmcnt(14)
    s_barrier
    s_waitcnt lgkmcnt(9)
    v_mfma_f32_16x16x32_bf16 v[140:143], a[120:123], v[72:75], v[140:143]
    ds_read_b64_tr_b16 a[144:145], v13 offset:18432
    v_mfma_f32_16x16x32_bf16 v[144:147], a[124:127], v[72:75], v[144:147]
    ds_read_b64_tr_b16 a[146:147], v13 offset:19200
    v_mfma_f32_16x16x32_bf16 v[148:151], a[128:131], v[72:75], v[148:151]
    ds_read_b64_tr_b16 a[148:149], v14 offset:18432
    v_mfma_f32_16x16x32_bf16 v[104:107], a[12:15], v[72:75], v[104:107]
    ds_read_b64_tr_b16 a[150:151], v14 offset:19200
    v_mfma_f32_16x16x32_bf16 v[108:111], a[16:19], v[72:75], v[108:111]
    ds_read_b64_tr_b16 a[152:153], v15 offset:18432
    v_mfma_f32_16x16x32_bf16 v[112:115], a[20:23], v[72:75], v[112:115]
    s_waitcnt lgkmcnt(6)
    v_mfma_f32_16x16x32_bf16 v[116:119], a[132:135], v[52:55], v[116:119]
    ds_read_b64_tr_b16 a[154:155], v15 offset:19200
    v_mfma_f32_16x16x32_bf16 v[120:123], a[136:139], v[52:55], v[120:123]
    s_add_u32 m0, s33, 16384
    v_mfma_f32_16x16x32_bf16 v[124:127], a[140:143], v[52:55], v[124:127]
    buffer_load_dwordx4 v22, s[12:15], 0 offen lds
    v_mfma_f32_16x16x32_bf16 v[80:83], a[24:27], v[52:55], v[80:83]
    v_add_u32 v22, 0x3000, v22
    v_mfma_f32_16x16x32_bf16 v[84:87], a[28:31], v[52:55], v[84:87]
    v_mfma_f32_16x16x32_bf16 v[88:91], a[32:35], v[52:55], v[88:91]
    ds_read_b128 v[44:47], v1 offset:0
    v_mfma_f32_16x16x32_bf16 v[128:131], a[132:135], v[64:67], v[128:131]
    s_add_u32 m0, s33, 20480
    v_mfma_f32_16x16x32_bf16 v[132:135], a[136:139], v[64:67], v[132:135]
    buffer_load_dwordx4 v23, s[12:15], 0 offen lds
    v_mfma_f32_16x16x32_bf16 v[136:139], a[140:143], v[64:67], v[136:139]
    v_add_u32 v23, 0x3000, v23
    v_mfma_f32_16x16x32_bf16 v[92:95], a[24:27], v[64:67], v[92:95]
    v_mfma_f32_16x16x32_bf16 v[96:99], a[28:31], v[64:67], v[96:99]
    v_mfma_f32_16x16x32_bf16 v[100:103], a[32:35], v[64:67], v[100:103]
    s_waitcnt lgkmcnt(7)
    v_mfma_f32_16x16x32_bf16 v[140:143], a[132:135], v[76:79], v[140:143]
    s_add_u32 m0, s33, 24576
    s_nop 0
    buffer_load_dwordx4 v21, s[12:15], 0 offen lds
    v_mfma_f32_16x16x32_bf16 v[144:147], a[136:139], v[76:79], v[144:147]
    v_add_u32 v21, 0x3000, v21
    v_mfma_f32_16x16x32_bf16 v[148:151], a[140:143], v[76:79], v[148:151]
    ds_read_b64_tr_b16 a[156:157], v13 offset:24576
    v_mfma_f32_16x16x32_bf16 v[104:107], a[24:27], v[76:79], v[104:107]
    ds_read_b64_tr_b16 a[158:159], v13 offset:25344
    v_mfma_f32_16x16x32_bf16 v[108:111], a[28:31], v[76:79], v[108:111]
    ds_read_b64_tr_b16 a[160:161], v14 offset:24576
    v_mfma_f32_16x16x32_bf16 v[112:115], a[32:35], v[76:79], v[112:115]
    s_waitcnt lgkmcnt(4)
    v_mfma_f32_16x16x32_bf16 v[116:119], a[144:147], v[56:59], v[116:119]
    ds_read_b64_tr_b16 a[162:163], v14 offset:25344
    v_mfma_f32_16x16x32_bf16 v[120:123], a[148:151], v[56:59], v[120:123]
    ds_read_b64_tr_b16 a[164:165], v15 offset:24576
    v_mfma_f32_16x16x32_bf16 v[124:127], a[152:155], v[56:59], v[124:127]
    ds_read_b64_tr_b16 a[166:167], v15 offset:25344
    v_mfma_f32_16x16x32_bf16 v[80:83], a[36:39], v[56:59], v[80:83]
    s_add_u32 m0, s33, 28672
    v_mfma_f32_16x16x32_bf16 v[84:87], a[40:43], v[56:59], v[84:87]
    buffer_load_dwordx4 v22, s[12:15], 0 offen lds
    v_mfma_f32_16x16x32_bf16 v[88:91], a[44:47], v[56:59], v[88:91]
    ds_read_b128 v[48:51], v1 offset:64
    v_mfma_f32_16x16x32_bf16 v[128:131], a[144:147], v[68:71], v[128:131]
    v_add_u32 v22, 0x3000, v22
    v_mfma_f32_16x16x32_bf16 v[132:135], a[148:151], v[68:71], v[132:135]
    s_add_u32 m0, s33, 32768
    v_mfma_f32_16x16x32_bf16 v[136:139], a[152:155], v[68:71], v[136:139]
    buffer_load_dwordx4 v23, s[12:15], 0 offen lds
    v_mfma_f32_16x16x32_bf16 v[92:95], a[36:39], v[68:71], v[92:95]
    v_add_u32 v23, 0x3000, v23
    v_mfma_f32_16x16x32_bf16 v[96:99], a[40:43], v[68:71], v[96:99]
    v_mfma_f32_16x16x32_bf16 v[100:103], a[44:47], v[68:71], v[100:103]
    s_waitcnt lgkmcnt(7)
    v_mfma_f32_16x16x32_bf16 v[140:143], a[144:147], v[44:47], v[140:143]
    s_add_u32 m0, s33, 36864
    s_nop 0
    buffer_load_dwordx4 v21, s[12:15], 0 offen lds
    v_mfma_f32_16x16x32_bf16 v[144:147], a[148:151], v[44:47], v[144:147]
    v_add_u32 v21, 0x3000, v21
    v_mfma_f32_16x16x32_bf16 v[148:151], a[152:155], v[44:47], v[148:151]
    ds_read_b64_tr_b16 a[168:169], v13 offset:30720
    v_mfma_f32_16x16x32_bf16 v[104:107], a[36:39], v[44:47], v[104:107]
    ds_read_b64_tr_b16 a[170:171], v13 offset:31488
    v_mfma_f32_16x16x32_bf16 v[108:111], a[40:43], v[44:47], v[108:111]
    ds_read_b64_tr_b16 a[172:173], v14 offset:30720
    v_mfma_f32_16x16x32_bf16 v[112:115], a[44:47], v[44:47], v[112:115]
    s_waitcnt lgkmcnt(4)
    v_mfma_f32_16x16x32_bf16 v[116:119], a[156:159], v[60:63], v[116:119]
    ds_read_b64_tr_b16 a[174:175], v14 offset:31488
    v_mfma_f32_16x16x32_bf16 v[120:123], a[160:163], v[60:63], v[120:123]
    ds_read_b64_tr_b16 a[176:177], v15 offset:30720
    v_mfma_f32_16x16x32_bf16 v[124:127], a[164:167], v[60:63], v[124:127]
    ds_read_b64_tr_b16 a[178:179], v15 offset:31488
    v_mfma_f32_16x16x32_bf16 v[80:83], a[48:51], v[60:63], v[80:83]
    s_add_u32 m0, s33, 40960
    v_mfma_f32_16x16x32_bf16 v[84:87], a[52:55], v[60:63], v[84:87]
    buffer_load_dwordx4 v22, s[12:15], 0 offen lds
    v_mfma_f32_16x16x32_bf16 v[88:91], a[56:59], v[60:63], v[88:91]
    ds_read_b128 v[52:55], v1 offset:128
    v_add_u32 v1, s63, v1
    v_mfma_f32_16x16x32_bf16 v[128:131], a[156:159], v[72:75], v[128:131]
    v_add_u32 v22, 0x3000, v22
    v_mfma_f32_16x16x32_bf16 v[132:135], a[160:163], v[72:75], v[132:135]
    s_add_u32 m0, s33, 45056
    v_mfma_f32_16x16x32_bf16 v[136:139], a[164:167], v[72:75], v[136:139]
    buffer_load_dwordx4 v23, s[12:15], 0 offen lds
    v_mfma_f32_16x16x32_bf16 v[92:95], a[48:51], v[72:75], v[92:95]
    v_add_u32 v23, 0x4800, v23
    v_mfma_f32_16x16x32_bf16 v[96:99], a[52:55], v[72:75], v[96:99]
    v_mfma_f32_16x16x32_bf16 v[100:103], a[56:59], v[72:75], v[100:103]
    s_add_u32 m0, s33, 49152
    s_nop 0
    buffer_load_dwordx4 v21, s[12:15], 0 offen lds
    v_add_u32 v21, 0x1800, v21
    s_waitcnt vmcnt(18)
    s_barrier
    s_waitcnt lgkmcnt(7)
    v_mfma_f32_16x16x32_bf16 v[140:143], a[156:159], v[48:51], v[140:143]
    ds_read_b64_tr_b16 a[180:181], v13 offset:36864
    v_mfma_f32_16x16x32_bf16 v[144:147], a[160:163], v[48:51], v[144:147]
    ds_read_b64_tr_b16 a[182:183], v13 offset:37632
    v_mfma_f32_16x16x32_bf16 v[148:151], a[164:167], v[48:51], v[148:151]
    ds_read_b64_tr_b16 a[184:185], v14 offset:36864
    v_mfma_f32_16x16x32_bf16 v[104:107], a[48:51], v[48:51], v[104:107]
    ds_read_b64_tr_b16 a[186:187], v14 offset:37632
    v_mfma_f32_16x16x32_bf16 v[108:111], a[52:55], v[48:51], v[108:111]
    ds_read_b64_tr_b16 a[188:189], v15 offset:36864
    v_mfma_f32_16x16x32_bf16 v[112:115], a[56:59], v[48:51], v[112:115]
    s_waitcnt lgkmcnt(6)
    v_mfma_f32_16x16x32_bf16 v[116:119], a[168:171], v[64:67], v[116:119]
    ds_read_b64_tr_b16 a[190:191], v15 offset:37632
    v_mfma_f32_16x16x32_bf16 v[120:123], a[172:175], v[64:67], v[120:123]
    s_mov_b32 m0, s35
    v_mfma_f32_16x16x32_bf16 v[124:127], a[176:179], v[64:67], v[124:127]
    buffer_load_dwordx4 v22, s[12:15], 0 offen lds
    v_mfma_f32_16x16x32_bf16 v[80:83], a[60:63], v[64:67], v[80:83]
    v_add_u32 v22, 0x1800, v22
    v_mfma_f32_16x16x32_bf16 v[84:87], a[64:67], v[64:67], v[84:87]
    v_mfma_f32_16x16x32_bf16 v[88:91], a[68:71], v[64:67], v[88:91]
    ds_read_b128 v[56:59], v37 offset:0
    v_mfma_f32_16x16x32_bf16 v[128:131], a[168:171], v[76:79], v[128:131]
    v_mfma_f32_16x16x32_bf16 v[132:135], a[172:175], v[76:79], v[132:135]
    v_mfma_f32_16x16x32_bf16 v[136:139], a[176:179], v[76:79], v[136:139]
    v_mfma_f32_16x16x32_bf16 v[92:95], a[60:63], v[76:79], v[92:95]
    v_mfma_f32_16x16x32_bf16 v[96:99], a[64:67], v[76:79], v[96:99]
    v_mfma_f32_16x16x32_bf16 v[100:103], a[68:71], v[76:79], v[100:103]
    s_waitcnt lgkmcnt(7)
    v_mfma_f32_16x16x32_bf16 v[140:143], a[168:171], v[52:55], v[140:143]
    ds_read_b64_tr_b16 a[192:193], v13 offset:43008
    v_mfma_f32_16x16x32_bf16 v[144:147], a[172:175], v[52:55], v[144:147]
    ds_read_b64_tr_b16 a[194:195], v13 offset:43776
    v_mfma_f32_16x16x32_bf16 v[148:151], a[176:179], v[52:55], v[148:151]
    ds_read_b64_tr_b16 a[196:197], v14 offset:43008
    v_mfma_f32_16x16x32_bf16 v[104:107], a[60:63], v[52:55], v[104:107]
    ds_read_b64_tr_b16 a[198:199], v14 offset:43776
    v_mfma_f32_16x16x32_bf16 v[108:111], a[64:67], v[52:55], v[108:111]
    ds_read_b64_tr_b16 a[200:201], v15 offset:43008
    v_mfma_f32_16x16x32_bf16 v[112:115], a[68:71], v[52:55], v[112:115]
    ds_read_b64_tr_b16 a[202:203], v15 offset:43776
    s_waitcnt vmcnt(5)
    s_barrier
    s_waitcnt lgkmcnt(7)
    v_mfma_f32_16x16x32_bf16 v[116:119], a[180:183], v[68:71], v[116:119]
    ds_read_b64_tr_b16 a[216:217], v24 offset:0
    ds_read_b64_tr_b16 a[218:219], v24 offset:768
    v_mfma_f32_16x16x32_bf16 v[120:123], a[184:187], v[68:71], v[120:123]
    ds_read_b64_tr_b16 a[220:221], v25 offset:0
    ds_read_b64_tr_b16 a[222:223], v25 offset:768
    v_mfma_f32_16x16x32_bf16 v[124:127], a[188:191], v[68:71], v[124:127]
    ds_read_b64_tr_b16 a[224:225], v26 offset:0
    ds_read_b64_tr_b16 a[226:227], v26 offset:768
    v_mfma_f32_16x16x32_bf16 v[80:83], a[72:75], v[68:71], v[80:83]
    ds_read_b64_tr_b16 a[228:229], v24 offset:6144
    v_mfma_f32_16x16x32_bf16 v[84:87], a[76:79], v[68:71], v[84:87]
    ds_read_b64_tr_b16 a[230:231], v24 offset:6912
    v_mfma_f32_16x16x32_bf16 v[88:91], a[80:83], v[68:71], v[88:91]
    ds_read_b128 v[60:63], v37 offset:64
    v_mfma_f32_16x16x32_bf16 v[128:131], a[180:183], v[44:47], v[128:131]
    ds_read_b64_tr_b16 a[232:233], v25 offset:6144
    ds_read_b64_tr_b16 a[234:235], v25 offset:6912
    v_mfma_f32_16x16x32_bf16 v[132:135], a[184:187], v[44:47], v[132:135]
    ds_read_b64_tr_b16 a[236:237], v26 offset:6144
    ds_read_b64_tr_b16 a[238:239], v26 offset:6912
    v_mfma_f32_16x16x32_bf16 v[136:139], a[188:191], v[44:47], v[136:139]
    ds_read_b64_tr_b16 a[240:241], v24 offset:12288
    v_mfma_f32_16x16x32_bf16 v[92:95], a[72:75], v[44:47], v[92:95]
    ds_read_b64_tr_b16 a[242:243], v24 offset:13056
    v_mfma_f32_16x16x32_bf16 v[96:99], a[76:79], v[44:47], v[96:99]
    ds_read_b64_tr_b16 a[244:245], v25 offset:12288
    v_mfma_f32_16x16x32_bf16 v[100:103], a[80:83], v[44:47], v[100:103]
    s_waitcnt lgkmcnt(15)
    v_mfma_f32_16x16x32_bf16 v[140:143], a[180:183], v[56:59], v[140:143]
    ds_read_b64_tr_b16 a[246:247], v25 offset:13056
    ds_read_b64_tr_b16 a[248:249], v26 offset:12288
    v_mfma_f32_16x16x32_bf16 v[144:147], a[184:187], v[56:59], v[144:147]
    ds_read_b64_tr_b16 a[250:251], v26 offset:13056
    ds_read_b64_tr_b16 a[204:205], v13 offset:49152
    v_mfma_f32_16x16x32_bf16 v[148:151], a[188:191], v[56:59], v[148:151]
    ds_read_b64_tr_b16 a[206:207], v13 offset:49920
    ds_read_b64_tr_b16 a[208:209], v14 offset:49152
    v_mfma_f32_16x16x32_bf16 v[104:107], a[72:75], v[56:59], v[104:107]
    ds_read_b64_tr_b16 a[210:211], v14 offset:49920
    ds_read_b64_tr_b16 a[212:213], v15 offset:49152
    v_mfma_f32_16x16x32_bf16 v[108:111], a[76:79], v[56:59], v[108:111]
    ds_read_b64_tr_b16 a[214:215], v15 offset:49920
    v_mfma_f32_16x16x32_bf16 v[112:115], a[80:83], v[56:59], v[112:115]
    v_mfma_f32_16x16x32_bf16 v[116:119], a[192:195], v[72:75], v[116:119]
    ds_read_b64_tr_b16 a[252:253], v24 offset:18432
    ds_read_b64_tr_b16 a[254:255], v24 offset:19200
    v_mfma_f32_16x16x32_bf16 v[120:123], a[196:199], v[72:75], v[120:123]
    ds_read_b64_tr_b16 v[188:189], v25 offset:18432
    ds_read_b64_tr_b16 v[190:191], v25 offset:19200
    v_mfma_f32_16x16x32_bf16 v[124:127], a[200:203], v[72:75], v[124:127]
    ds_read_b64_tr_b16 v[192:193], v26 offset:18432
    ds_read_b64_tr_b16 v[194:195], v26 offset:19200
    v_mfma_f32_16x16x32_bf16 v[80:83], a[84:87], v[72:75], v[80:83]
    ds_read_b64_tr_b16 v[196:197], v24 offset:24576
    v_mfma_f32_16x16x32_bf16 v[84:87], a[88:91], v[72:75], v[84:87]
    ds_read_b64_tr_b16 v[198:199], v24 offset:25344
    v_mfma_f32_16x16x32_bf16 v[88:91], a[92:95], v[72:75], v[88:91]
    ds_read_b128 v[64:67], v37 offset:128
    v_add_u32 v37, s63, v37
    v_mfma_f32_16x16x32_bf16 v[128:131], a[192:195], v[48:51], v[128:131]
    ds_read_b64_tr_b16 v[200:201], v25 offset:24576
    ds_read_b64_tr_b16 v[202:203], v25 offset:25344
    v_mfma_f32_16x16x32_bf16 v[132:135], a[196:199], v[48:51], v[132:135]
    ds_read_b64_tr_b16 v[204:205], v26 offset:24576
    ds_read_b64_tr_b16 v[206:207], v26 offset:25344
    v_mfma_f32_16x16x32_bf16 v[136:139], a[200:203], v[48:51], v[136:139]
    ds_read_b64_tr_b16 v[208:209], v24 offset:30720
    v_mfma_f32_16x16x32_bf16 v[92:95], a[84:87], v[48:51], v[92:95]
    ds_read_b64_tr_b16 v[210:211], v24 offset:31488
    v_mfma_f32_16x16x32_bf16 v[96:99], a[88:91], v[48:51], v[96:99]
    ds_read_b64_tr_b16 v[212:213], v25 offset:30720
    v_mfma_f32_16x16x32_bf16 v[100:103], a[92:95], v[48:51], v[100:103]
    ds_read_b64_tr_b16 v[214:215], v25 offset:31488
    ds_read_b64_tr_b16 v[216:217], v26 offset:30720
    ds_read_b64_tr_b16 v[218:219], v26 offset:31488
    s_lshr_b32 s56, s56, 4
    s_and_b32 s62, s56, 15
    s_mul_i32 s62, s62, 10240
    s_sub_u32 s63, s62, s58
    s_mov_b32 s58, s62
    s_waitcnt lgkmcnt(15)
    s_waitcnt lgkmcnt(0)
    s_waitcnt vmcnt(0)
    s_barrier
    v_mfma_f32_16x16x32_bf16 v[140:143], a[192:195], v[60:63], v[140:143]
    ds_read_b64_tr_b16 v[220:221], v24 offset:36864
    ds_read_b64_tr_b16 v[222:223], v24 offset:37632
    v_mfma_f32_16x16x32_bf16 v[144:147], a[196:199], v[60:63], v[144:147]
    ds_read_b64_tr_b16 v[224:225], v25 offset:36864
    ds_read_b64_tr_b16 v[226:227], v25 offset:37632
    v_mfma_f32_16x16x32_bf16 v[148:151], a[200:203], v[60:63], v[148:151]
    ds_read_b64_tr_b16 v[228:229], v26 offset:36864
    ds_read_b64_tr_b16 v[230:231], v26 offset:37632
    v_mfma_f32_16x16x32_bf16 v[104:107], a[84:87], v[60:63], v[104:107]
    ds_read_b64_tr_b16 v[232:233], v24 offset:43008
    ds_read_b64_tr_b16 v[234:235], v24 offset:43776
    v_mfma_f32_16x16x32_bf16 v[108:111], a[88:91], v[60:63], v[108:111]
    ds_read_b64_tr_b16 v[236:237], v25 offset:43008
    ds_read_b64_tr_b16 v[238:239], v25 offset:43776
    v_mfma_f32_16x16x32_bf16 v[112:115], a[92:95], v[60:63], v[112:115]
    v_mfma_f32_16x16x32_bf16 v[116:119], a[204:207], v[76:79], v[116:119]
    ds_read_b128 v[44:47], v27 offset:0
    ds_read_b128 v[68:71], v0 offset:0
    v_mfma_f32_16x16x32_bf16 v[120:123], a[208:211], v[76:79], v[120:123]
    ds_read_b64_tr_b16 v[240:241], v26 offset:43008
    ds_read_b64_tr_b16 v[242:243], v26 offset:43776
    v_mfma_f32_16x16x32_bf16 v[124:127], a[212:215], v[76:79], v[124:127]
    ds_read_b64_tr_b16 v[244:245], v24 offset:49152
    ds_read_b64_tr_b16 v[246:247], v24 offset:49920
    v_mfma_f32_16x16x32_bf16 v[80:83], a[96:99], v[76:79], v[80:83]
    ds_read_b64_tr_b16 v[248:249], v25 offset:49152
    ds_read_b64_tr_b16 v[250:251], v25 offset:49920
    v_mfma_f32_16x16x32_bf16 v[84:87], a[100:103], v[76:79], v[84:87]
    ds_read_b64_tr_b16 v[252:253], v26 offset:49152
    ds_read_b64_tr_b16 v[254:255], v26 offset:49920
    v_mfma_f32_16x16x32_bf16 v[88:91], a[104:107], v[76:79], v[88:91]
    v_mfma_f32_16x16x32_bf16 v[128:131], a[204:207], v[52:55], v[128:131]
    ds_read_b128 v[48:51], v27 offset:64
    ds_read_b128 v[72:75], v0 offset:64
    v_mfma_f32_16x16x32_bf16 v[132:135], a[208:211], v[52:55], v[132:135]
    s_and_b32 s41, s57, 15
    s_mul_i32 s41, s41, 10240
    v_mfma_f32_16x16x32_bf16 v[136:139], a[212:215], v[52:55], v[136:139]
    s_add_u32 s60, s41, s30
    s_lshr_b32 s57, s57, 4
    v_mfma_f32_16x16x32_bf16 v[92:95], a[96:99], v[52:55], v[92:95]
    s_add_u32 m0, s60, 0
    s_nop 0
    buffer_load_dwordx4 v16, s[8:11], 0 offen nt lds
    v_mfma_f32_16x16x32_bf16 v[96:99], a[100:103], v[52:55], v[96:99]
    v_add_u32 v16, s31, v16
    s_add_u32 m0, s60, 1024
    v_mfma_f32_16x16x32_bf16 v[100:103], a[104:107], v[52:55], v[100:103]
    v_mfma_f32_16x16x32_bf16 v[140:143], a[204:207], v[64:67], v[140:143]
    ds_read_b128 v[52:55], v27 offset:128
    v_add_u32 v27, s63, v27
    v_mfma_f32_16x16x32_bf16 v[144:147], a[208:211], v[64:67], v[144:147]
    ds_read_b128 v[76:79], v0 offset:128
    v_add_u32 v0, s63, v0
    v_mfma_f32_16x16x32_bf16 v[148:151], a[212:215], v[64:67], v[148:151]
    buffer_load_dwordx4 v17, s[8:11], 0 offen nt lds
    v_add_u32 v17, s31, v17
    v_mfma_f32_16x16x32_bf16 v[104:107], a[96:99], v[64:67], v[104:107]
    s_add_u32 m0, s60, 2048
    s_nop 0
    buffer_load_dwordx4 v18, s[8:11], 0 offen nt lds
    v_mfma_f32_16x16x32_bf16 v[108:111], a[100:103], v[64:67], v[108:111]
    v_add_u32 v18, s31, v18
    v_mfma_f32_16x16x32_bf16 v[112:115], a[104:107], v[64:67], v[112:115]
    s_add_u32 m0, s60, 3072
    s_nop 0
    buffer_load_dwordx4 v19, s[8:11], 0 offen nt lds
    v_add_u32 v19, s31, v19
    s_add_u32 m0, s60, 4096
    s_nop 0
    buffer_load_dwordx4 v20, s[8:11], 0 offen nt lds
    v_add_u32 v20, s31, v20
L_loop:
    s_waitcnt lgkmcnt(5)
    v_mfma_f32_16x16x32_bf16 v[152:155], a[216:219], v[44:47], v[116:119]
    ds_read_b128 v[56:59], v29 offset:0
    s_waitcnt lgkmcnt(4)
    v_mfma_f32_16x16x32_bf16 v[152:155], a[228:231], v[48:51], v[152:155]
    ds_read_b128 v[60:63], v29 offset:64
    s_waitcnt lgkmcnt(3)
    v_mfma_f32_16x16x32_bf16 v[152:155], a[240:243], v[52:55], v[152:155]
    ds_read_b128 v[64:67], v29 offset:128
    v_mfma_f32_16x16x32_bf16 v[156:159], a[220:223], v[44:47], v[120:123]
    v_add_u32 v29, s63, v29
    v_mfma_f32_16x16x32_bf16 v[156:159], a[232:235], v[48:51], v[156:159]
    v_mfma_f32_16x16x32_bf16 v[156:159], a[244:247], v[52:55], v[156:159]
    v_cvt_pk_bf16_f32 v38, v176, v177
    v_cvt_pk_bf16_f32 v39, v178, v179
    v_mfma_f32_16x16x32_bf16 v[160:163], a[224:227], v[44:47], v[124:127]
    ds_write_b64 v30, v[38:39] offset:832
    v_mfma_f32_16x16x32_bf16 v[160:163], a[236:239], v[48:51], v[160:163]
    v_cvt_pk_bf16_f32 v40, v180, v181
    v_mfma_f32_16x16x32_bf16 v[160:163], a[248:251], v[52:55], v[160:163]
    v_mfma_f32_16x16x32_bf16 v[116:119], a[108:111], v[44:47], v[80:83]
    v_cvt_pk_bf16_f32 v41, v182, v183
    v_mfma_f32_16x16x32_bf16 v[116:119], a[120:123], v[48:51], v[116:119]
    ds_write_b64 v30, v[40:41] offset:840
    v_mfma_f32_16x16x32_bf16 v[116:119], a[132:135], v[52:55], v[116:119]
    v_cvt_pk_bf16_f32 v42, v184, v185
    v_mfma_f32_16x16x32_bf16 v[120:123], a[112:115], v[44:47], v[84:87]
    v_cvt_pk_bf16_f32 v43, v186, v187
    v_mfma_f32_16x16x32_bf16 v[120:123], a[124:127], v[48:51], v[120:123]
    ds_write_b64 v30, v[42:43] offset:848
    v_mfma_f32_16x16x32_bf16 v[120:123], a[136:139], v[52:55], v[120:123]
    v_mfma_f32_16x16x32_bf16 v[124:127], a[116:119], v[44:47], v[88:91]
    v_mfma_f32_16x16x32_bf16 v[124:127], a[128:131], v[48:51], v[124:127]
    v_mfma_f32_16x16x32_bf16 v[124:127], a[140:143], v[52:55], v[124:127]
    v_mfma_f32_16x16x32_bf16 v[80:83], a[0:3], v[44:47], 0
    s_cmp_eq_u32 s61, 3
    s_cselect_b32 s31, s40, 147456
    v_mfma_f32_16x16x32_bf16 v[80:83], a[12:15], v[48:51], v[80:83]
    s_cmp_ge_u32 s61, 5
    v_mfma_f32_16x16x32_bf16 v[80:83], a[24:27], v[52:55], v[80:83]
    s_cselect_b32 s10, 0, 28311552
    v_mfma_f32_16x16x32_bf16 v[84:87], a[4:7], v[44:47], 0
    s_and_b32 s41, s57, 15
    v_mfma_f32_16x16x32_bf16 v[84:87], a[16:19], v[48:51], v[84:87]
    s_mul_i32 s41, s41, 10240
    v_mfma_f32_16x16x32_bf16 v[84:87], a[28:31], v[52:55], v[84:87]
    s_add_u32 s60, s41, s30
    v_mfma_f32_16x16x32_bf16 v[88:91], a[8:11], v[44:47], 0
    s_lshr_b32 s57, s57, 4
    v_mfma_f32_16x16x32_bf16 v[88:91], a[20:23], v[48:51], v[88:91]
    v_mfma_f32_16x16x32_bf16 v[88:91], a[32:35], v[52:55], v[88:91]
    s_waitcnt lgkmcnt(0)
    s_barrier
    v_mfma_f32_16x16x32_bf16 v[152:155], a[252:255], v[56:59], v[152:155]
    ds_read_b128 v[44:47], v1 offset:0
    v_mfma_f32_16x16x32_bf16 v[152:155], v[196:199], v[60:63], v[152:155]
    ds_read_b128 v[4:7], v31
    v_mfma_f32_16x16x32_bf16 v[152:155], v[208:211], v[64:67], v[152:155]
    ds_read_b128 v[8:11], v32
    v_mfma_f32_16x16x32_bf16 v[152:155], v[220:223], v[68:71], v[152:155]
    ds_read_b128 v[12:15], v33
    v_mfma_f32_16x16x32_bf16 v[152:155], v[232:235], v[72:75], v[152:155]
    s_add_u32 m0, s60, 0
    v_mfma_f32_16x16x32_bf16 v[152:155], v[244:247], v[76:79], v[152:155]
    buffer_load_dwordx4 v16, s[8:11], 0 offen nt lds
    v_mfma_f32_16x16x32_bf16 v[156:159], v[188:191], v[56:59], v[156:159]
    v_add_u32 v16, s31, v16
    v_mfma_f32_16x16x32_bf16 v[156:159], v[200:203], v[60:63], v[156:159]
    v_mfma_f32_16x16x32_bf16 v[156:159], v[212:215], v[64:67], v[156:159]
    v_mfma_f32_16x16x32_bf16 v[156:159], v[224:227], v[68:71], v[156:159]
    s_waitcnt lgkmcnt(2)
    buffer_store_dwordx4 v[4:7], v36, s[16:19], 0 offen offset:0 sc1
    v_mfma_f32_16x16x32_bf16 v[156:159], v[236:239], v[72:75], v[156:159]
    ds_read_b128 v[4:7], v34
    v_mfma_f32_16x16x32_bf16 v[156:159], v[248:251], v[76:79], v[156:159]
    v_mfma_f32_16x16x32_bf16 v[160:163], v[192:195], v[56:59], v[160:163]
    v_mfma_f32_16x16x32_bf16 v[160:163], v[204:207], v[60:63], v[160:163]
    s_add_u32 m0, s60, 1024
    v_mfma_f32_16x16x32_bf16 v[160:163], v[216:219], v[64:67], v[160:163]
    buffer_load_dwordx4 v17, s[8:11], 0 offen nt lds
    v_mfma_f32_16x16x32_bf16 v[160:163], v[228:231], v[68:71], v[160:163]
    v_add_u32 v17, s31, v17
    v_mfma_f32_16x16x32_bf16 v[160:163], v[240:243], v[72:75], v[160:163]
    v_mfma_f32_16x16x32_bf16 v[160:163], v[252:255], v[76:79], v[160:163]
    v_mfma_f32_16x16x32_bf16 v[116:119], a[144:147], v[56:59], v[116:119]
    ds_read_b128 v[48:51], v1 offset:64
    v_mfma_f32_16x16x32_bf16 v[116:119], a[156:159], v[60:63], v[116:119]
    s_waitcnt lgkmcnt(3)
    buffer_store_dwordx4 v[8:11], v36, s[16:19], 0 offen offset:1024 sc1
    v_mfma_f32_16x16x32_bf16 v[116:119], a[168:171], v[64:67], v[116:119]
    ds_read_b128 v[8:11], v35
    v_mfma_f32_16x16x32_bf16 v[116:119], a[180:183], v[68:71], v[116:119]
    v_mfma_f32_16x16x32_bf16 v[116:119], a[192:195], v[72:75], v[116:119]
    s_add_u32 m0, s60, 2048
    v_mfma_f32_16x16x32_bf16 v[116:119], a[204:207], v[76:79], v[116:119]
    buffer_load_dwordx4 v18, s[8:11], 0 offen nt lds
    v_mfma_f32_16x16x32_bf16 v[120:123], a[148:151], v[56:59], v[120:123]
    v_add_u32 v18, s31, v18
    v_mfma_f32_16x16x32_bf16 v[120:123], a[160:163], v[60:63], v[120:123]
    v_mfma_f32_16x16x32_bf16 v[120:123], a[172:175], v[64:67], v[120:123]
    v_mfma_f32_16x16x32_bf16 v[120:123], a[184:187], v[68:71], v[120:123]
    s_waitcnt lgkmcnt(3)
    buffer_store_dwordx4 v[12:15], v36, s[16:19], 0 offen offset:2048 sc1
    v_mfma_f32_16x16x32_bf16 v[120:123], a[196:199], v[72:75], v[120:123]
    v_mfma_f32_16x16x32_bf16 v[120:123], a[208:211], v[76:79], v[120:123]
    v_mfma_f32_16x16x32_bf16 v[124:127], a[152:155], v[56:59], v[124:127]
    v_mfma_f32_16x16x32_bf16 v[124:127], a[164:167], v[60:63], v[124:127]
    s_add_u32 m0, s60, 3072
    v_mfma_f32_16x16x32_bf16 v[124:127], a[176:179], v[64:67], v[124:127]
    buffer_load_dwordx4 v19, s[8:11], 0 offen nt lds
    v_mfma_f32_16x16x32_bf16 v[124:127], a[188:191], v[68:71], v[124:127]
    v_add_u32 v19, s31, v19
    v_mfma_f32_16x16x32_bf16 v[124:127], a[200:203], v[72:75], v[124:127]
    v_mfma_f32_16x16x32_bf16 v[124:127], a[212:215], v[76:79], v[124:127]
    v_mfma_f32_16x16x32_bf16 v[80:83], a[36:39], v[56:59], v[80:83]
    ds_read_b128 v[52:55], v1 offset:128
    v_mfma_f32_16x16x32_bf16 v[80:83], a[48:51], v[60:63], v[80:83]
    v_add_u32 v1, s63, v1
    v_mfma_f32_16x16x32_bf16 v[80:83], a[60:63], v[64:67], v[80:83]
    s_waitcnt lgkmcnt(3)
    buffer_store_dwordx4 v[4:7], v36, s[16:19], 0 offen offset:3072 sc1
    v_mfma_f32_16x16x32_bf16 v[80:83], a[72:75], v[68:71], v[80:83]
    v_mfma_f32_16x16x32_bf16 v[80:83], a[84:87], v[72:75], v[80:83]
    s_add_u32 m0, s60, 4096
    v_mfma_f32_16x16x32_bf16 v[80:83], a[96:99], v[76:79], v[80:83]
    buffer_load_dwordx4 v20, s[8:11], 0 offen nt lds
    v_mfma_f32_16x16x32_bf16 v[84:87], a[40:43], v[56:59], v[84:87]
    v_add_u32 v20, s31, v20
    v_mfma_f32_16x16x32_bf16 v[84:87], a[52:55], v[60:63], v[84:87]
    v_mfma_f32_16x16x32_bf16 v[84:87], a[64:67], v[64:67], v[84:87]
    v_mfma_f32_16x16x32_bf16 v[84:87], a[76:79], v[68:71], v[84:87]
    s_waitcnt lgkmcnt(1)
    buffer_store_dwordx4 v[8:11], v36, s[84:87], 0 offen sc1
    v_mfma_f32_16x16x32_bf16 v[84:87], a[88:91], v[72:75], v[84:87]
    v_add_u32 v36, 147456, v36
    v_mfma_f32_16x16x32_bf16 v[84:87], a[100:103], v[76:79], v[84:87]
    s_mov_b32 s86, s88
    v_mfma_f32_16x16x32_bf16 v[88:91], a[44:47], v[56:59], v[88:91]
    s_mov_b32 s18, 28311552
    v_mfma_f32_16x16x32_bf16 v[88:91], a[56:59], v[60:63], v[88:91]
    v_mfma_f32_16x16x32_bf16 v[88:91], a[68:71], v[64:67], v[88:91]
    v_mfma_f32_16x16x32_bf16 v[88:91], a[80:83], v[68:71], v[88:91]
    v_mfma_f32_16x16x32_bf16 v[88:91], a[92:95], v[72:75], v[88:91]
    v_mfma_f32_16x16x32_bf16 v[88:91], a[104:107], v[76:79], v[88:91]
    v_mfma_f32_16x16x32_bf16 v[164:167], a[216:219], v[56:59], v[128:131]
    v_mfma_f32_16x16x32_bf16 v[164:167], a[228:231], v[60:63], v[164:167]
    v_mfma_f32_16x16x32_bf16 v[164:167], a[240:243], v[64:67], v[164:167]
    v_mfma_f32_16x16x32_bf16 v[164:167], a[252:255], v[68:71], v[164:167]
    v_mfma_f32_16x16x32_bf16 v[164:167], v[196:199], v[72:75], v[164:167]
    v_mfma_f32_16x16x32_bf16 v[164:167], v[208:211], v[76:79], v[164:167]
    v_mfma_f32_16x16x32_bf16 v[164:167], v[220:223], v[44:47], v[164:167]
    v_mfma_f32_16x16x32_bf16 v[164:167], v[232:235], v[48:51], v[164:167]
    s_waitcnt lgkmcnt(0)
    v_mfma_f32_16x16x32_bf16 v[164:167], v[244:247], v[52:55], v[164:167]
    v_mfma_f32_16x16x32_bf16 v[168:171], a[220:223], v[56:59], v[132:135]
    v_mfma_f32_16x16x32_bf16 v[168:171], a[232:235], v[60:63], v[168:171]
    v_mfma_f32_16x16x32_bf16 v[168:171], a[244:247], v[64:67], v[168:171]
    v_mfma_f32_16x16x32_bf16 v[168:171], v[188:191], v[68:71], v[168:171]
    v_mfma_f32_16x16x32_bf16 v[168:171], v[200:203], v[72:75], v[168:171]
    v_mfma_f32_16x16x32_bf16 v[168:171], v[212:215], v[76:79], v[168:171]
    v_mfma_f32_16x16x32_bf16 v[168:171], v[224:227], v[44:47], v[168:171]
    v_mfma_f32_16x16x32_bf16 v[168:171], v[236:239], v[48:51], v[168:171]
    v_mfma_f32_16x16x32_bf16 v[168:171], v[248:251], v[52:55], v[168:171]
    v_mfma_f32_16x16x32_bf16 v[172:175], a[224:227], v[56:59], v[136:139]
    v_mfma_f32_16x16x32_bf16 v[172:175], a[236:239], v[60:63], v[172:175]
    v_mfma_f32_16x16x32_bf16 v[172:175], a[248:251], v[64:67], v[172:175]
    v_mfma_f32_16x16x32_bf16 v[172:175], v[192:195], v[68:71], v[172:175]
    v_mfma_f32_16x16x32_bf16 v[172:175], v[204:207], v[72:75], v[172:175]
    v_mfma_f32_16x16x32_bf16 v[172:175], v[216:219], v[76:79], v[172:175]
    v_mfma_f32_16x16x32_bf16 v[172:175], v[228:231], v[44:47], v[172:175]
    v_mfma_f32_16x16x32_bf16 v[172:175], v[240:243], v[48:51], v[172:175]
    v_mfma_f32_16x16x32_bf16 v[172:175], v[252:255], v[52:55], v[172:175]
    v_mfma_f32_16x16x32_bf16 v[128:131], a[108:111], v[56:59], v[92:95]
    v_mfma_f32_16x16x32_bf16 v[128:131], a[120:123], v[60:63], v[128:131]
    v_mfma_f32_16x16x32_bf16 v[128:131], a[132:135], v[64:67], v[128:131]
    v_mfma_f32_16x16x32_bf16 v[128:131], a[144:147], v[68:71], v[128:131]
    v_mfma_f32_16x16x32_bf16 v[128:131], a[156:159], v[72:75], v[128:131]
    v_mfma_f32_16x16x32_bf16 v[128:131], a[168:171], v[76:79], v[128:131]
    v_mfma_f32_16x16x32_bf16 v[128:131], a[180:183], v[44:47], v[128:131]
    v_mfma_f32_16x16x32_bf16 v[128:131], a[192:195], v[48:51], v[128:131]
    v_mfma_f32_16x16x32_bf16 v[128:131], a[204:207], v[52:55], v[128:131]
    v_mfma_f32_16x16x32_bf16 v[132:135], a[112:115], v[56:59], v[96:99]
    v_mfma_f32_16x16x32_bf16 v[132:135], a[124:127], v[60:63], v[132:135]
    v_mfma_f32_16x16x32_bf16 v[132:135], a[136:139], v[64:67], v[132:135]
    v_mfma_f32_16x16x32_bf16 v[132:135], a[148:151], v[68:71], v[132:135]
    v_mfma_f32_16x16x32_bf16 v[132:135], a[160:163], v[72:75], v[132:135]
    v_mfma_f32_16x16x32_bf16 v[132:135], a[172:175], v[76:79], v[132:135]
    v_mfma_f32_16x16x32_bf16 v[132:135], a[184:187], v[44:47], v[132:135]
    v_mfma_f32_16x16x32_bf16 v[132:135], a[196:199], v[48:51], v[132:135]
    v_mfma_f32_16x16x32_bf16 v[132:135], a[208:211], v[52:55], v[132:135]
    v_mfma_f32_16x16x32_bf16 v[136:139], a[116:119], v[56:59], v[100:103]
    v_mfma_f32_16x16x32_bf16 v[136:139], a[128:131], v[60:63], v[136:139]
    v_mfma_f32_16x16x32_bf16 v[136:139], a[140:143], v[64:67], v[136:139]
    v_mfma_f32_16x16x32_bf16 v[136:139], a[152:155], v[68:71], v[136:139]
    v_mfma_f32_16x16x32_bf16 v[136:139], a[164:167], v[72:75], v[136:139]
    v_mfma_f32_16x16x32_bf16 v[136:139], a[176:179], v[76:79], v[136:139]
    v_mfma_f32_16x16x32_bf16 v[136:139], a[188:191], v[44:47], v[136:139]
    v_mfma_f32_16x16x32_bf16 v[136:139], a[200:203], v[48:51], v[136:139]
    v_mfma_f32_16x16x32_bf16 v[136:139], a[212:215], v[52:55], v[136:139]
    v_mfma_f32_16x16x32_bf16 v[92:95], a[0:3], v[56:59], 0
    v_mfma_f32_16x16x32_bf16 v[92:95], a[12:15], v[60:63], v[92:95]
    v_mfma_f32_16x16x32_bf16 v[92:95], a[24:27], v[64:67], v[92:95]
    v_mfma_f32_16x16x32_bf16 v[92:95], a[36:39], v[68:71], v[92:95]
    v_mfma_f32_16x16x32_bf16 v[92:95], a[48:51], v[72:75], v[92:95]
    v_mfma_f32_16x16x32_bf16 v[92:95], a[60:63], v[76:79], v[92:95]
    v_mfma_f32_16x16x32_bf16 v[92:95], a[72:75], v[44:47], v[92:95]
    v_mfma_f32_16x16x32_bf16 v[92:95], a[84:87], v[48:51], v[92:95]
    v_mfma_f32_16x16x32_bf16 v[92:95], a[96:99], v[52:55], v[92:95]
    v_mfma_f32_16x16x32_bf16 v[96:99], a[4:7], v[56:59], 0
    v_mfma_f32_16x16x32_bf16 v[96:99], a[16:19], v[60:63], v[96:99]
    v_mfma_f32_16x16x32_bf16 v[96:99], a[28:31], v[64:67], v[96:99]
    v_mfma_f32_16x16x32_bf16 v[96:99], a[40:43], v[68:71], v[96:99]
    v_mfma_f32_16x16x32_bf16 v[96:99], a[52:55], v[72:75], v[96:99]
    v_mfma_f32_16x16x32_bf16 v[96:99], a[64:67], v[76:79], v[96:99]
    v_mfma_f32_16x16x32_bf16 v[96:99], a[76:79], v[44:47], v[96:99]
    v_mfma_f32_16x16x32_bf16 v[96:99], a[88:91], v[48:51], v[96:99]
    v_mfma_f32_16x16x32_bf16 v[96:99], a[100:103], v[52:55], v[96:99]
    v_mfma_f32_16x16x32_bf16 v[100:103], a[8:11], v[56:59], 0
    v_mfma_f32_16x16x32_bf16 v[100:103], a[20:23], v[60:63], v[100:103]
    v_mfma_f32_16x16x32_bf16 v[100:103], a[32:35], v[64:67], v[100:103]
    v_mfma_f32_16x16x32_bf16 v[100:103], a[44:47], v[68:71], v[100:103]
    v_mfma_f32_16x16x32_bf16 v[100:103], a[56:59], v[72:75], v[100:103]
    v_mfma_f32_16x16x32_bf16 v[100:103], a[68:71], v[76:79], v[100:103]
    v_mfma_f32_16x16x32_bf16 v[100:103], a[80:83], v[44:47], v[100:103]
    v_mfma_f32_16x16x32_bf16 v[100:103], a[92:95], v[48:51], v[100:103]
    v_mfma_f32_16x16x32_bf16 v[100:103], a[104:107], v[52:55], v[100:103]
    s_waitcnt vmcnt(10)
    s_barrier
    v_mfma_f32_16x16x32_bf16 v[176:179], a[216:219], v[68:71], v[140:143]
    ds_read_b128 v[56:59], v37 offset:0
    v_mfma_f32_16x16x32_bf16 v[176:179], a[228:231], v[72:75], v[176:179]
    ds_read_b128 v[60:63], v37 offset:64
    v_mfma_f32_16x16x32_bf16 v[176:179], a[240:243], v[76:79], v[176:179]
    v_mfma_f32_16x16x32_bf16 v[176:179], a[252:255], v[44:47], v[176:179]
    v_mfma_f32_16x16x32_bf16 v[176:179], v[196:199], v[48:51], v[176:179]
    v_mfma_f32_16x16x32_bf16 v[176:179], v[208:211], v[52:55], v[176:179]
    v_mfma_f32_16x16x32_bf16 v[180:183], a[220:223], v[68:71], v[144:147]
    v_mfma_f32_16x16x32_bf16 v[180:183], a[232:235], v[72:75], v[180:183]
    v_mfma_f32_16x16x32_bf16 v[180:183], a[244:247], v[76:79], v[180:183]
    v_cvt_pk_bf16_f32 v38, v152, v153
    v_cvt_pk_bf16_f32 v39, v154, v155
    v_mfma_f32_16x16x32_bf16 v[180:183], v[188:191], v[44:47], v[180:183]
    ds_write_b64 v30, v[38:39] offset:0
    v_mfma_f32_16x16x32_bf16 v[180:183], v[200:203], v[48:51], v[180:183]
    v_cvt_pk_bf16_f32 v40, v156, v157
    v_mfma_f32_16x16x32_bf16 v[180:183], v[212:215], v[52:55], v[180:183]
    v_cvt_pk_bf16_f32 v41, v158, v159
    v_mfma_f32_16x16x32_bf16 v[184:187], a[224:227], v[68:71], v[148:151]
    ds_write_b64 v30, v[40:41] offset:8
    v_mfma_f32_16x16x32_bf16 v[184:187], a[236:239], v[72:75], v[184:187]
    v_cvt_pk_bf16_f32 v42, v160, v161
    v_mfma_f32_16x16x32_bf16 v[184:187], a[248:251], v[76:79], v[184:187]
    v_cvt_pk_bf16_f32 v43, v162, v163
    v_mfma_f32_16x16x32_bf16 v[184:187], v[192:195], v[44:47], v[184:187]
    ds_write_b64 v30, v[42:43] offset:16
    v_mfma_f32_16x16x32_bf16 v[184:187], v[204:207], v[48:51], v[184:187]
    v_mfma_f32_16x16x32_bf16 v[184:187], v[216:219], v[52:55], v[184:187]
    v_mfma_f32_16x16x32_bf16 v[140:143], a[108:111], v[68:71], v[104:107]
    ds_read_b128 v[64:67], v37 offset:128
    v_mfma_f32_16x16x32_bf16 v[140:143], a[120:123], v[72:75], v[140:143]
    v_add_u32 v37, s63, v37
    v_mfma_f32_16x16x32_bf16 v[140:143], a[132:135], v[76:79], v[140:143]
    s_lshr_b32 s56, s56, 4
    v_mfma_f32_16x16x32_bf16 v[140:143], a[144:147], v[44:47], v[140:143]
    s_and_b32 s62, s56, 15
    v_mfma_f32_16x16x32_bf16 v[140:143], a[156:159], v[48:51], v[140:143]
    s_mul_i32 s62, s62, 10240
    v_mfma_f32_16x16x32_bf16 v[140:143], a[168:171], v[52:55], v[140:143]
    s_sub_u32 s63, s62, s58
    v_mfma_f32_16x16x32_bf16 v[144:147], a[112:115], v[68:71], v[108:111]
    s_mov_b32 s58, s62
    v_mfma_f32_16x16x32_bf16 v[144:147], a[124:127], v[72:75], v[144:147]
    v_mfma_f32_16x16x32_bf16 v[144:147], a[136:139], v[76:79], v[144:147]
    v_mfma_f32_16x16x32_bf16 v[144:147], a[148:151], v[44:47], v[144:147]
    v_cvt_pk_bf16_f32 v38, v164, v165
    v_cvt_pk_bf16_f32 v39, v166, v167
    v_mfma_f32_16x16x32_bf16 v[144:147], a[160:163], v[48:51], v[144:147]
    ds_write_b64 v30, v[38:39] offset:416
    v_mfma_f32_16x16x32_bf16 v[144:147], a[172:175], v[52:55], v[144:147]
    v_cvt_pk_bf16_f32 v40, v168, v169
    v_mfma_f32_16x16x32_bf16 v[148:151], a[116:119], v[68:71], v[112:115]
    v_cvt_pk_bf16_f32 v41, v170, v171
    v_mfma_f32_16x16x32_bf16 v[148:151], a[128:131], v[72:75], v[148:151]
    ds_write_b64 v30, v[40:41] offset:424
    v_mfma_f32_16x16x32_bf16 v[148:151], a[140:143], v[76:79], v[148:151]
    v_cvt_pk_bf16_f32 v42, v172, v173
    v_mfma_f32_16x16x32_bf16 v[148:151], a[152:155], v[44:47], v[148:151]
    v_cvt_pk_bf16_f32 v43, v174, v175
    v_mfma_f32_16x16x32_bf16 v[148:151], a[164:167], v[48:51], v[148:151]
    ds_write_b64 v30, v[42:43] offset:432
    v_mfma_f32_16x16x32_bf16 v[148:151], a[176:179], v[52:55], v[148:151]
    v_mfma_f32_16x16x32_bf16 v[104:107], a[0:3], v[68:71], 0
    v_mfma_f32_16x16x32_bf16 v[104:107], a[12:15], v[72:75], v[104:107]
    v_mfma_f32_16x16x32_bf16 v[104:107], a[24:27], v[76:79], v[104:107]
    v_mfma_f32_16x16x32_bf16 v[104:107], a[36:39], v[44:47], v[104:107]
    v_mfma_f32_16x16x32_bf16 v[104:107], a[48:51], v[48:51], v[104:107]
    v_mfma_f32_16x16x32_bf16 v[104:107], a[60:63], v[52:55], v[104:107]
    v_mfma_f32_16x16x32_bf16 v[108:111], a[4:7], v[68:71], 0
    v_mfma_f32_16x16x32_bf16 v[108:111], a[16:19], v[72:75], v[108:111]
    v_mfma_f32_16x16x32_bf16 v[108:111], a[28:31], v[76:79], v[108:111]
    v_mfma_f32_16x16x32_bf16 v[108:111], a[40:43], v[44:47], v[108:111]
    v_mfma_f32_16x16x32_bf16 v[108:111], a[52:55], v[48:51], v[108:111]
    v_mfma_f32_16x16x32_bf16 v[108:111], a[64:67], v[52:55], v[108:111]
    v_mfma_f32_16x16x32_bf16 v[112:115], a[8:11], v[68:71], 0
    v_mfma_f32_16x16x32_bf16 v[112:115], a[20:23], v[72:75], v[112:115]
    v_mfma_f32_16x16x32_bf16 v[112:115], a[32:35], v[76:79], v[112:115]
    v_mfma_f32_16x16x32_bf16 v[112:115], a[44:47], v[44:47], v[112:115]
    v_mfma_f32_16x16x32_bf16 v[112:115], a[56:59], v[48:51], v[112:115]
    v_mfma_f32_16x16x32_bf16 v[112:115], a[68:71], v[52:55], v[112:115]
    s_waitcnt lgkmcnt(8)
    v_mfma_f32_16x16x32_bf16 v[176:179], v[220:223], v[56:59], v[176:179]
    ds_read_b128 v[44:47], v27 offset:0
    s_waitcnt lgkmcnt(8)
    v_mfma_f32_16x16x32_bf16 v[176:179], v[232:235], v[60:63], v[176:179]
    ds_read_b128 v[68:71], v0 offset:0
    s_waitcnt lgkmcnt(5)
    v_mfma_f32_16x16x32_bf16 v[176:179], v[244:247], v[64:67], v[176:179]
    v_mfma_f32_16x16x32_bf16 v[180:183], v[224:227], v[56:59], v[180:183]
    v_mfma_f32_16x16x32_bf16 v[180:183], v[236:239], v[60:63], v[180:183]
    v_mfma_f32_16x16x32_bf16 v[180:183], v[248:251], v[64:67], v[180:183]
    v_mfma_f32_16x16x32_bf16 v[184:187], v[228:231], v[56:59], v[184:187]
    v_mfma_f32_16x16x32_bf16 v[184:187], v[240:243], v[60:63], v[184:187]
    v_mfma_f32_16x16x32_bf16 v[184:187], v[252:255], v[64:67], v[184:187]
    v_mfma_f32_16x16x32_bf16 v[140:143], a[180:183], v[56:59], v[140:143]
    ds_read_b128 v[48:51], v27 offset:64
    v_mfma_f32_16x16x32_bf16 v[140:143], a[192:195], v[60:63], v[140:143]
    ds_read_b128 v[72:75], v0 offset:64
    v_mfma_f32_16x16x32_bf16 v[140:143], a[204:207], v[64:67], v[140:143]
    v_mfma_f32_16x16x32_bf16 v[144:147], a[184:187], v[56:59], v[144:147]
    v_mfma_f32_16x16x32_bf16 v[144:147], a[196:199], v[60:63], v[144:147]
    v_mfma_f32_16x16x32_bf16 v[144:147], a[208:211], v[64:67], v[144:147]
    v_mfma_f32_16x16x32_bf16 v[148:151], a[188:191], v[56:59], v[148:151]
    v_mfma_f32_16x16x32_bf16 v[148:151], a[200:203], v[60:63], v[148:151]
    v_mfma_f32_16x16x32_bf16 v[148:151], a[212:215], v[64:67], v[148:151]
    v_mfma_f32_16x16x32_bf16 v[104:107], a[72:75], v[56:59], v[104:107]
    ds_read_b128 v[52:55], v27 offset:128
    v_mfma_f32_16x16x32_bf16 v[104:107], a[84:87], v[60:63], v[104:107]
    v_add_u32 v27, s63, v27
    v_mfma_f32_16x16x32_bf16 v[104:107], a[96:99], v[64:67], v[104:107]
    ds_read_b128 v[76:79], v0 offset:128
    v_mfma_f32_16x16x32_bf16 v[108:111], a[76:79], v[56:59], v[108:111]
    v_add_u32 v0, s63, v0
    v_mfma_f32_16x16x32_bf16 v[108:111], a[88:91], v[60:63], v[108:111]
    v_mfma_f32_16x16x32_bf16 v[108:111], a[100:103], v[64:67], v[108:111]
    v_mfma_f32_16x16x32_bf16 v[112:115], a[80:83], v[56:59], v[112:115]
    s_add_u32 s61, s61, 1
    v_mfma_f32_16x16x32_bf16 v[112:115], a[92:95], v[60:63], v[112:115]
    s_cmp_lt_u32 s61, 6
    v_mfma_f32_16x16x32_bf16 v[112:115], a[104:107], v[64:67], v[112:115]
    s_cbranch_scc1 L_loop
    s_waitcnt lgkmcnt(5)
    v_mfma_f32_16x16x32_bf16 v[152:155], a[216:219], v[44:47], v[116:119]
    ds_read_b128 v[56:59], v29 offset:0
    s_waitcnt lgkmcnt(4)
    v_mfma_f32_16x16x32_bf16 v[152:155], a[228:231], v[48:51], v[152:155]
    ds_read_b128 v[60:63], v29 offset:64
    s_waitcnt lgkmcnt(3)
    v_mfma_f32_16x16x32_bf16 v[152:155], a[240:243], v[52:55], v[152:155]
    ds_read_b128 v[64:67], v29 offset:128
    v_mfma_f32_16x16x32_bf16 v[156:159], a[220:223], v[44:47], v[120:123]
    v_add_u32 v29, s63, v29
    v_cvt_pk_bf16_f32 v38, v176, v177
    v_mfma_f32_16x16x32_bf16 v[156:159], a[232:235], v[48:51], v[156:159]
    v_cvt_pk_bf16_f32 v39, v178, v179
    ds_write_b64 v30, v[38:39] offset:832
    v_mfma_f32_16x16x32_bf16 v[156:159], a[244:247], v[52:55], v[156:159]
    v_mfma_f32_16x16x32_bf16 v[160:163], a[224:227], v[44:47], v[124:127]
    v_cvt_pk_bf16_f32 v40, v180, v181
    v_mfma_f32_16x16x32_bf16 v[160:163], a[236:239], v[48:51], v[160:163]
    v_cvt_pk_bf16_f32 v41, v182, v183
    v_mfma_f32_16x16x32_bf16 v[160:163], a[248:251], v[52:55], v[160:163]
    ds_write_b64 v30, v[40:41] offset:840
    v_mfma_f32_16x16x32_bf16 v[116:119], a[108:111], v[44:47], v[80:83]
    v_cvt_pk_bf16_f32 v42, v184, v185
    v_mfma_f32_16x16x32_bf16 v[116:119], a[120:123], v[48:51], v[116:119]
    v_cvt_pk_bf16_f32 v43, v186, v187
    v_mfma_f32_16x16x32_bf16 v[116:119], a[132:135], v[52:55], v[116:119]
    v_mfma_f32_16x16x32_bf16 v[120:123], a[112:115], v[44:47], v[84:87]
    ds_write_b64 v30, v[42:43] offset:848
    v_mfma_f32_16x16x32_bf16 v[120:123], a[124:127], v[48:51], v[120:123]
    v_mfma_f32_16x16x32_bf16 v[120:123], a[136:139], v[52:55], v[120:123]
    v_mfma_f32_16x16x32_bf16 v[124:127], a[116:119], v[44:47], v[88:91]
    v_mfma_f32_16x16x32_bf16 v[124:127], a[128:131], v[48:51], v[124:127]
    v_mfma_f32_16x16x32_bf16 v[124:127], a[140:143], v[52:55], v[124:127]
    s_waitcnt lgkmcnt(0)
    s_barrier
    v_mfma_f32_16x16x32_bf16 v[152:155], a[252:255], v[56:59], v[152:155]
    ds_read_b128 v[44:47], v1 offset:0
    v_mfma_f32_16x16x32_bf16 v[152:155], v[196:199], v[60:63], v[152:155]
    ds_read_b128 v[4:7], v31
    v_mfma_f32_16x16x32_bf16 v[152:155], v[208:211], v[64:67], v[152:155]
    ds_read_b128 v[8:11], v32
    v_mfma_f32_16x16x32_bf16 v[152:155], v[220:223], v[68:71], v[152:155]
    ds_read_b128 v[12:15], v33
    v_mfma_f32_16x16x32_bf16 v[152:155], v[232:235], v[72:75], v[152:155]
    v_mfma_f32_16x16x32_bf16 v[152:155], v[244:247], v[76:79], v[152:155]
    v_mfma_f32_16x16x32_bf16 v[156:159], v[188:191], v[56:59], v[156:159]
    s_waitcnt lgkmcnt(2)
    buffer_store_dwordx4 v[4:7], v36, s[16:19], 0 offen offset:0 sc1
    v_mfma_f32_16x16x32_bf16 v[156:159], v[200:203], v[60:63], v[156:159]
    ds_read_b128 v[4:7], v34
    v_mfma_f32_16x16x32_bf16 v[156:159], v[212:215], v[64:67], v[156:159]
    v_mfma_f32_16x16x32_bf16 v[156:159], v[224:227], v[68:71], v[156:159]
    v_mfma_f32_16x16x32_bf16 v[156:159], v[236:239], v[72:75], v[156:159]
    v_mfma_f32_16x16x32_bf16 v[156:159], v[248:251], v[76:79], v[156:159]
    v_mfma_f32_16x16x32_bf16 v[160:163], v[192:195], v[56:59], v[160:163]
    ds_read_b128 v[48:51], v1 offset:64
    v_mfma_f32_16x16x32_bf16 v[160:163], v[204:207], v[60:63], v[160:163]
    s_waitcnt lgkmcnt(3)
    buffer_store_dwordx4 v[8:11], v36, s[16:19], 0 offen offset:1024 sc1
    v_mfma_f32_16x16x32_bf16 v[160:163], v[216:219], v[64:67], v[160:163]
    ds_read_b128 v[8:11], v35
    v_mfma_f32_16x16x32_bf16 v[160:163], v[228:231], v[68:71], v[160:163]
    v_mfma_f32_16x16x32_bf16 v[160:163], v[240:243], v[72:75], v[160:163]
    v_mfma_f32_16x16x32_bf16 v[160:163], v[252:255], v[76:79], v[160:163]
    v_mfma_f32_16x16x32_bf16 v[116:119], a[144:147], v[56:59], v[116:119]
    s_waitcnt lgkmcnt(3)
    buffer_store_dwordx4 v[12:15], v36, s[16:19], 0 offen offset:2048 sc1
    v_mfma_f32_16x16x32_bf16 v[116:119], a[156:159], v[60:63], v[116:119]
    v_mfma_f32_16x16x32_bf16 v[116:119], a[168:171], v[64:67], v[116:119]
    v_mfma_f32_16x16x32_bf16 v[116:119], a[180:183], v[68:71], v[116:119]
    v_mfma_f32_16x16x32_bf16 v[116:119], a[192:195], v[72:75], v[116:119]
    v_mfma_f32_16x16x32_bf16 v[116:119], a[204:207], v[76:79], v[116:119]
    v_mfma_f32_16x16x32_bf16 v[120:123], a[148:151], v[56:59], v[120:123]
    ds_read_b128 v[52:55], v1 offset:128
    v_mfma_f32_16x16x32_bf16 v[120:123], a[160:163], v[60:63], v[120:123]
    v_add_u32 v1, s63, v1
    v_mfma_f32_16x16x32_bf16 v[120:123], a[172:175], v[64:67], v[120:123]
    s_waitcnt lgkmcnt(3)
    buffer_store_dwordx4 v[4:7], v36, s[16:19], 0 offen offset:3072 sc1
    v_mfma_f32_16x16x32_bf16 v[120:123], a[184:187], v[68:71], v[120:123]
    v_mfma_f32_16x16x32_bf16 v[120:123], a[196:199], v[72:75], v[120:123]
    v_mfma_f32_16x16x32_bf16 v[120:123], a[208:211], v[76:79], v[120:123]
    v_mfma_f32_16x16x32_bf16 v[124:127], a[152:155], v[56:59], v[124:127]
    s_waitcnt lgkmcnt(1)
    buffer_store_dwordx4 v[8:11], v36, s[84:87], 0 offen sc1
    v_mfma_f32_16x16x32_bf16 v[124:127], a[164:167], v[60:63], v[124:127]
    v_add_u32 v36, 147456, v36
    v_mfma_f32_16x16x32_bf16 v[124:127], a[176:179], v[64:67], v[124:127]
    s_mov_b32 s86, s88
    v_mfma_f32_16x16x32_bf16 v[124:127], a[188:191], v[68:71], v[124:127]
    s_mov_b32 s18, 28311552
    v_mfma_f32_16x16x32_bf16 v[124:127], a[200:203], v[72:75], v[124:127]
    v_mfma_f32_16x16x32_bf16 v[124:127], a[212:215], v[76:79], v[124:127]
    v_mfma_f32_16x16x32_bf16 v[164:167], a[216:219], v[56:59], v[128:131]
    v_mfma_f32_16x16x32_bf16 v[164:167], a[228:231], v[60:63], v[164:167]
    v_mfma_f32_16x16x32_bf16 v[164:167], a[240:243], v[64:67], v[164:167]
    v_mfma_f32_16x16x32_bf16 v[164:167], a[252:255], v[68:71], v[164:167]
    v_mfma_f32_16x16x32_bf16 v[164:167], v[196:199], v[72:75], v[164:167]
    v_mfma_f32_16x16x32_bf16 v[164:167], v[208:211], v[76:79], v[164:167]
    v_mfma_f32_16x16x32_bf16 v[164:167], v[220:223], v[44:47], v[164:167]
    v_mfma_f32_16x16x32_bf16 v[164:167], v[232:235], v[48:51], v[164:167]
    s_waitcnt lgkmcnt(0)
    v_mfma_f32_16x16x32_bf16 v[164:167], v[244:247], v[52:55], v[164:167]
    v_mfma_f32_16x16x32_bf16 v[168:171], a[220:223], v[56:59], v[132:135]
    v_mfma_f32_16x16x32_bf16 v[168:171], a[232:235], v[60:63], v[168:171]
    v_mfma_f32_16x16x32_bf16 v[168:171], a[244:247], v[64:67], v[168:171]
    v_mfma_f32_16x16x32_bf16 v[168:171], v[188:191], v[68:71], v[168:171]
    v_mfma_f32_16x16x32_bf16 v[168:171], v[200:203], v[72:75], v[168:171]
    v_mfma_f32_16x16x32_bf16 v[168:171], v[212:215], v[76:79], v[168:171]
    v_mfma_f32_16x16x32_bf16 v[168:171], v[224:227], v[44:47], v[168:171]
    v_mfma_f32_16x16x32_bf16 v[168:171], v[236:239], v[48:51], v[168:171]
    v_mfma_f32_16x16x32_bf16 v[168:171], v[248:251], v[52:55], v[168:171]
    v_mfma_f32_16x16x32_bf16 v[172:175], a[224:227], v[56:59], v[136:139]
    v_mfma_f32_16x16x32_bf16 v[172:175], a[236:239], v[60:63], v[172:175]
    v_mfma_f32_16x16x32_bf16 v[172:175], a[248:251], v[64:67], v[172:175]
    v_mfma_f32_16x16x32_bf16 v[172:175], v[192:195], v[68:71], v[172:175]
    v_mfma_f32_16x16x32_bf16 v[172:175], v[204:207], v[72:75], v[172:175]
    v_mfma_f32_16x16x32_bf16 v[172:175], v[216:219], v[76:79], v[172:175]
    v_mfma_f32_16x16x32_bf16 v[172:175], v[228:231], v[44:47], v[172:175]
    v_mfma_f32_16x16x32_bf16 v[172:175], v[240:243], v[48:51], v[172:175]
    v_mfma_f32_16x16x32_bf16 v[172:175], v[252:255], v[52:55], v[172:175]
    v_mfma_f32_16x16x32_bf16 v[128:131], a[108:111], v[56:59], v[92:95]
    v_mfma_f32_16x16x32_bf16 v[128:131], a[120:123], v[60:63], v[128:131]
    v_mfma_f32_16x16x32_bf16 v[128:131], a[132:135], v[64:67], v[128:131]
    v_mfma_f32_16x16x32_bf16 v[128:131], a[144:147], v[68:71], v[128:131]
    v_mfma_f32_16x16x32_bf16 v[128:131], a[156:159], v[72:75], v[128:131]
    v_mfma_f32_16x16x32_bf16 v[128:131], a[168:171], v[76:79], v[128:131]
    v_mfma_f32_16x16x32_bf16 v[128:131], a[180:183], v[44:47], v[128:131]
    v_mfma_f32_16x16x32_bf16 v[128:131], a[192:195], v[48:51], v[128:131]
    v_mfma_f32_16x16x32_bf16 v[128:131], a[204:207], v[52:55], v[128:131]
    v_mfma_f32_16x16x32_bf16 v[132:135], a[112:115], v[56:59], v[96:99]
    v_mfma_f32_16x16x32_bf16 v[132:135], a[124:127], v[60:63], v[132:135]
    v_mfma_f32_16x16x32_bf16 v[132:135], a[136:139], v[64:67], v[132:135]
    v_mfma_f32_16x16x32_bf16 v[132:135], a[148:151], v[68:71], v[132:135]
    v_mfma_f32_16x16x32_bf16 v[132:135], a[160:163], v[72:75], v[132:135]
    v_mfma_f32_16x16x32_bf16 v[132:135], a[172:175], v[76:79], v[132:135]
    v_mfma_f32_16x16x32_bf16 v[132:135], a[184:187], v[44:47], v[132:135]
    v_mfma_f32_16x16x32_bf16 v[132:135], a[196:199], v[48:51], v[132:135]
    v_mfma_f32_16x16x32_bf16 v[132:135], a[208:211], v[52:55], v[132:135]
    v_mfma_f32_16x16x32_bf16 v[136:139], a[116:119], v[56:59], v[100:103]
    v_mfma_f32_16x16x32_bf16 v[136:139], a[128:131], v[60:63], v[136:139]
    v_mfma_f32_16x16x32_bf16 v[136:139], a[140:143], v[64:67], v[136:139]
    v_mfma_f32_16x16x32_bf16 v[136:139], a[152:155], v[68:71], v[136:139]
    v_mfma_f32_16x16x32_bf16 v[136:139], a[164:167], v[72:75], v[136:139]
    v_mfma_f32_16x16x32_bf16 v[136:139], a[176:179], v[76:79], v[136:139]
    v_mfma_f32_16x16x32_bf16 v[136:139], a[188:191], v[44:47], v[136:139]
    v_mfma_f32_16x16x32_bf16 v[136:139], a[200:203], v[48:51], v[136:139]
    v_mfma_f32_16x16x32_bf16 v[136:139], a[212:215], v[52:55], v[136:139]
    s_barrier
    v_mfma_f32_16x16x32_bf16 v[176:179], a[216:219], v[68:71], v[140:143]
    ds_read_b128 v[56:59], v37 offset:0
    v_mfma_f32_16x16x32_bf16 v[176:179], a[228:231], v[72:75], v[176:179]
    ds_read_b128 v[60:63], v37 offset:64
    v_mfma_f32_16x16x32_bf16 v[176:179], a[240:243], v[76:79], v[176:179]
    v_mfma_f32_16x16x32_bf16 v[176:179], a[252:255], v[44:47], v[176:179]
    v_mfma_f32_16x16x32_bf16 v[176:179], v[196:199], v[48:51], v[176:179]
    v_mfma_f32_16x16x32_bf16 v[176:179], v[208:211], v[52:55], v[176:179]
    v_cvt_pk_bf16_f32 v38, v152, v153
    v_cvt_pk_bf16_f32 v39, v154, v155
    v_mfma_f32_16x16x32_bf16 v[180:183], a[220:223], v[68:71], v[144:147]
    ds_write_b64 v30, v[38:39] offset:0
    v_mfma_f32_16x16x32_bf16 v[180:183], a[232:235], v[72:75], v[180:183]
    v_cvt_pk_bf16_f32 v40, v156, v157
    v_mfma_f32_16x16x32_bf16 v[180:183], a[244:247], v[76:79], v[180:183]
    v_cvt_pk_bf16_f32 v41, v158, v159
    v_mfma_f32_16x16x32_bf16 v[180:183], v[188:191], v[44:47], v[180:183]
    ds_write_b64 v30, v[40:41] offset:8
    v_mfma_f32_16x16x32_bf16 v[180:183], v[200:203], v[48:51], v[180:183]
    v_cvt_pk_bf16_f32 v42, v160, v161
    v_mfma_f32_16x16x32_bf16 v[180:183], v[212:215], v[52:55], v[180:183]
    v_mfma_f32_16x16x32_bf16 v[184:187], a[224:227], v[68:71], v[148:151]
    ds_read_b128 v[64:67], v37 offset:128
    v_mfma_f32_16x16x32_bf16 v[184:187], a[236:239], v[72:75], v[184:187]
    v_add_u32 v37, s63, v37
    v_mfma_f32_16x16x32_bf16 v[184:187], a[248:251], v[76:79], v[184:187]
    v_cvt_pk_bf16_f32 v43, v162, v163
    v_mfma_f32_16x16x32_bf16 v[184:187], v[192:195], v[44:47], v[184:187]
    ds_write_b64 v30, v[42:43] offset:16
    v_mfma_f32_16x16x32_bf16 v[184:187], v[204:207], v[48:51], v[184:187]
    v_mfma_f32_16x16x32_bf16 v[184:187], v[216:219], v[52:55], v[184:187]
    v_cvt_pk_bf16_f32 v38, v164, v165
    v_cvt_pk_bf16_f32 v39, v166, v167
    v_mfma_f32_16x16x32_bf16 v[140:143], a[108:111], v[68:71], v[104:107]
    ds_write_b64 v30, v[38:39] offset:416
    v_mfma_f32_16x16x32_bf16 v[140:143], a[120:123], v[72:75], v[140:143]
    v_cvt_pk_bf16_f32 v40, v168, v169
    v_mfma_f32_16x16x32_bf16 v[140:143], a[132:135], v[76:79], v[140:143]
    v_cvt_pk_bf16_f32 v41, v170, v171
    v_mfma_f32_16x16x32_bf16 v[140:143], a[144:147], v[44:47], v[140:143]
    ds_write_b64 v30, v[40:41] offset:424
    v_mfma_f32_16x16x32_bf16 v[140:143], a[156:159], v[48:51], v[140:143]
    v_cvt_pk_bf16_f32 v42, v172, v173
    v_mfma_f32_16x16x32_bf16 v[140:143], a[168:171], v[52:55], v[140:143]
    v_mfma_f32_16x16x32_bf16 v[144:147], a[112:115], v[68:71], v[108:111]
    v_cvt_pk_bf16_f32 v43, v174, v175
    v_mfma_f32_16x16x32_bf16 v[144:147], a[124:127], v[72:75], v[144:147]
    ds_write_b64 v30, v[42:43] offset:432
    v_mfma_f32_16x16x32_bf16 v[144:147], a[136:139], v[76:79], v[144:147]
    v_mfma_f32_16x16x32_bf16 v[144:147], a[148:151], v[44:47], v[144:147]
    v_mfma_f32_16x16x32_bf16 v[144:147], a[160:163], v[48:51], v[144:147]
    v_mfma_f32_16x16x32_bf16 v[144:147], a[172:175], v[52:55], v[144:147]
    v_mfma_f32_16x16x32_bf16 v[148:151], a[116:119], v[68:71], v[112:115]
    v_mfma_f32_16x16x32_bf16 v[148:151], a[128:131], v[72:75], v[148:151]
    v_mfma_f32_16x16x32_bf16 v[148:151], a[140:143], v[76:79], v[148:151]
    v_mfma_f32_16x16x32_bf16 v[148:151], a[152:155], v[44:47], v[148:151]
    v_mfma_f32_16x16x32_bf16 v[148:151], a[164:167], v[48:51], v[148:151]
    v_mfma_f32_16x16x32_bf16 v[148:151], a[176:179], v[52:55], v[148:151]
    s_waitcnt lgkmcnt(8)
    v_mfma_f32_16x16x32_bf16 v[176:179], v[220:223], v[56:59], v[176:179]
    ds_read_b128 v[44:47], v27 offset:0
    s_waitcnt lgkmcnt(8)
    v_mfma_f32_16x16x32_bf16 v[176:179], v[232:235], v[60:63], v[176:179]
    ds_read_b128 v[68:71], v0 offset:0
    s_waitcnt lgkmcnt(6)
    v_mfma_f32_16x16x32_bf16 v[176:179], v[244:247], v[64:67], v[176:179]
    v_mfma_f32_16x16x32_bf16 v[180:183], v[224:227], v[56:59], v[180:183]
    v_mfma_f32_16x16x32_bf16 v[180:183], v[236:239], v[60:63], v[180:183]
    v_mfma_f32_16x16x32_bf16 v[180:183], v[248:251], v[64:67], v[180:183]
    v_mfma_f32_16x16x32_bf16 v[184:187], v[228:231], v[56:59], v[184:187]
    ds_read_b128 v[48:51], v27 offset:64
    v_mfma_f32_16x16x32_bf16 v[184:187], v[240:243], v[60:63], v[184:187]
    ds_read_b128 v[72:75], v0 offset:64
    v_mfma_f32_16x16x32_bf16 v[184:187], v[252:255], v[64:67], v[184:187]
    v_mfma_f32_16x16x32_bf16 v[140:143], a[180:183], v[56:59], v[140:143]
    v_mfma_f32_16x16x32_bf16 v[140:143], a[192:195], v[60:63], v[140:143]
    v_mfma_f32_16x16x32_bf16 v[140:143], a[204:207], v[64:67], v[140:143]
    v_mfma_f32_16x16x32_bf16 v[144:147], a[184:187], v[56:59], v[144:147]
    ds_read_b128 v[52:55], v27 offset:128
    v_mfma_f32_16x16x32_bf16 v[144:147], a[196:199], v[60:63], v[144:147]
    ds_read_b128 v[76:79], v0 offset:128
    v_mfma_f32_16x16x32_bf16 v[144:147], a[208:211], v[64:67], v[144:147]
    v_mfma_f32_16x16x32_bf16 v[148:151], a[188:191], v[56:59], v[148:151]
    v_mfma_f32_16x16x32_bf16 v[148:151], a[200:203], v[60:63], v[148:151]
    v_mfma_f32_16x16x32_bf16 v[148:151], a[212:215], v[64:67], v[148:151]
    s_waitcnt lgkmcnt(5)
    v_mfma_f32_16x16x32_bf16 v[152:155], a[216:219], v[44:47], v[116:119]
    ds_read_b128 v[56:59], v29 offset:0
    s_waitcnt lgkmcnt(4)
    v_mfma_f32_16x16x32_bf16 v[152:155], a[228:231], v[48:51], v[152:155]
    ds_read_b128 v[60:63], v29 offset:64
    ds_read_b128 v[64:67], v29 offset:128
    s_waitcnt lgkmcnt(4)
    v_mfma_f32_16x16x32_bf16 v[152:155], a[240:243], v[52:55], v[152:155]
    v_cvt_pk_bf16_f32 v38, v176, v177
    v_cvt_pk_bf16_f32 v39, v178, v179
    v_mfma_f32_16x16x32_bf16 v[156:159], a[220:223], v[44:47], v[120:123]
    ds_write_b64 v30, v[38:39] offset:832
    v_mfma_f32_16x16x32_bf16 v[156:159], a[232:235], v[48:51], v[156:159]
    v_cvt_pk_bf16_f32 v40, v180, v181
    v_mfma_f32_16x16x32_bf16 v[156:159], a[244:247], v[52:55], v[156:159]
    v_cvt_pk_bf16_f32 v41, v182, v183
    v_mfma_f32_16x16x32_bf16 v[160:163], a[224:227], v[44:47], v[124:127]
    ds_write_b64 v30, v[40:41] offset:840
    v_mfma_f32_16x16x32_bf16 v[160:163], a[236:239], v[48:51], v[160:163]
    v_cvt_pk_bf16_f32 v42, v184, v185
    v_mfma_f32_16x16x32_bf16 v[160:163], a[248:251], v[52:55], v[160:163]
    v_cvt_pk_bf16_f32 v43, v186, v187
    s_waitcnt lgkmcnt(4)
    v_mfma_f32_16x16x32_bf16 v[152:155], a[252:255], v[56:59], v[152:155]
    ds_read_b128 v[44:47], v1 offset:0
    s_waitcnt lgkmcnt(4)
    v_mfma_f32_16x16x32_bf16 v[152:155], v[196:199], v[60:63], v[152:155]
    ds_write_b64 v30, v[42:43] offset:848
    s_waitcnt lgkmcnt(4)
    v_mfma_f32_16x16x32_bf16 v[152:155], v[208:211], v[64:67], v[152:155]
    v_mfma_f32_16x16x32_bf16 v[152:155], v[220:223], v[68:71], v[152:155]
    v_mfma_f32_16x16x32_bf16 v[152:155], v[232:235], v[72:75], v[152:155]
    v_mfma_f32_16x16x32_bf16 v[152:155], v[244:247], v[76:79], v[152:155]
    s_waitcnt lgkmcnt(0)
    s_barrier
    v_mfma_f32_16x16x32_bf16 v[156:159], v[188:191], v[56:59], v[156:159]
    ds_read_b128 v[48:51], v1 offset:64
    v_mfma_f32_16x16x32_bf16 v[156:159], v[200:203], v[60:63], v[156:159]
    ds_read_b128 v[4:7], v31
    v_mfma_f32_16x16x32_bf16 v[156:159], v[212:215], v[64:67], v[156:159]
    ds_read_b128 v[8:11], v32
    v_mfma_f32_16x16x32_bf16 v[156:159], v[224:227], v[68:71], v[156:159]
    ds_read_b128 v[12:15], v33
    v_mfma_f32_16x16x32_bf16 v[156:159], v[236:239], v[72:75], v[156:159]
    s_waitcnt lgkmcnt(2)
    buffer_store_dwordx4 v[4:7], v36, s[16:19], 0 offen offset:0 sc1
    v_mfma_f32_16x16x32_bf16 v[156:159], v[248:251], v[76:79], v[156:159]
    v_mfma_f32_16x16x32_bf16 v[160:163], v[192:195], v[56:59], v[160:163]
    ds_read_b128 v[52:55], v1 offset:128
    v_mfma_f32_16x16x32_bf16 v[160:163], v[204:207], v[60:63], v[160:163]
    ds_read_b128 v[4:7], v34
    v_mfma_f32_16x16x32_bf16 v[160:163], v[216:219], v[64:67], v[160:163]
    s_waitcnt lgkmcnt(3)
    buffer_store_dwordx4 v[8:11], v36, s[16:19], 0 offen offset:1024 sc1
    v_mfma_f32_16x16x32_bf16 v[160:163], v[228:231], v[68:71], v[160:163]
    ds_read_b128 v[8:11], v35
    v_mfma_f32_16x16x32_bf16 v[160:163], v[240:243], v[72:75], v[160:163]
    s_waitcnt lgkmcnt(3)
    buffer_store_dwordx4 v[12:15], v36, s[16:19], 0 offen offset:2048 sc1
    v_mfma_f32_16x16x32_bf16 v[160:163], v[252:255], v[76:79], v[160:163]
    v_mfma_f32_16x16x32_bf16 v[164:167], a[216:219], v[56:59], v[128:131]
    s_waitcnt lgkmcnt(1)
    buffer_store_dwordx4 v[4:7], v36, s[16:19], 0 offen offset:3072 sc1
    v_mfma_f32_16x16x32_bf16 v[164:167], a[228:231], v[60:63], v[164:167]
    v_mfma_f32_16x16x32_bf16 v[164:167], a[240:243], v[64:67], v[164:167]
    v_mfma_f32_16x16x32_bf16 v[164:167], a[252:255], v[68:71], v[164:167]
    s_waitcnt lgkmcnt(0)
    buffer_store_dwordx4 v[8:11], v36, s[84:87], 0 offen sc1
    v_mfma_f32_16x16x32_bf16 v[164:167], v[196:199], v[72:75], v[164:167]
    v_add_u32 v36, 147456, v36
    v_mfma_f32_16x16x32_bf16 v[164:167], v[208:211], v[76:79], v[164:167]
    s_mov_b32 s86, s88
    v_mfma_f32_16x16x32_bf16 v[164:167], v[220:223], v[44:47], v[164:167]
    s_mov_b32 s18, 28311552
    v_mfma_f32_16x16x32_bf16 v[164:167], v[232:235], v[48:51], v[164:167]
    v_mfma_f32_16x16x32_bf16 v[164:167], v[244:247], v[52:55], v[164:167]
    v_mfma_f32_16x16x32_bf16 v[168:171], a[220:223], v[56:59], v[132:135]
    v_mfma_f32_16x16x32_bf16 v[168:171], a[232:235], v[60:63], v[168:171]
    v_mfma_f32_16x16x32_bf16 v[168:171], a[244:247], v[64:67], v[168:171]
    v_mfma_f32_16x16x32_bf16 v[168:171], v[188:191], v[68:71], v[168:171]
    v_mfma_f32_16x16x32_bf16 v[168:171], v[200:203], v[72:75], v[168:171]
    v_mfma_f32_16x16x32_bf16 v[168:171], v[212:215], v[76:79], v[168:171]
    v_mfma_f32_16x16x32_bf16 v[168:171], v[224:227], v[44:47], v[168:171]
    v_mfma_f32_16x16x32_bf16 v[168:171], v[236:239], v[48:51], v[168:171]
    v_mfma_f32_16x16x32_bf16 v[168:171], v[248:251], v[52:55], v[168:171]
    v_mfma_f32_16x16x32_bf16 v[172:175], a[224:227], v[56:59], v[136:139]
    v_mfma_f32_16x16x32_bf16 v[172:175], a[236:239], v[60:63], v[172:175]
    v_mfma_f32_16x16x32_bf16 v[172:175], a[248:251], v[64:67], v[172:175]
    v_mfma_f32_16x16x32_bf16 v[172:175], v[192:195], v[68:71], v[172:175]
    v_mfma_f32_16x16x32_bf16 v[172:175], v[204:207], v[72:75], v[172:175]
    v_mfma_f32_16x16x32_bf16 v[172:175], v[216:219], v[76:79], v[172:175]
    v_mfma_f32_16x16x32_bf16 v[172:175], v[228:231], v[44:47], v[172:175]
    v_mfma_f32_16x16x32_bf16 v[172:175], v[240:243], v[48:51], v[172:175]
    v_mfma_f32_16x16x32_bf16 v[172:175], v[252:255], v[52:55], v[172:175]
    s_barrier
    v_mfma_f32_16x16x32_bf16 v[176:179], a[216:219], v[68:71], v[140:143]
    ds_read_b128 v[56:59], v37 offset:0
    v_mfma_f32_16x16x32_bf16 v[176:179], a[228:231], v[72:75], v[176:179]
    ds_read_b128 v[60:63], v37 offset:64
    v_mfma_f32_16x16x32_bf16 v[176:179], a[240:243], v[76:79], v[176:179]
    v_cvt_pk_bf16_f32 v38, v152, v153
    v_cvt_pk_bf16_f32 v39, v154, v155
    v_mfma_f32_16x16x32_bf16 v[176:179], a[252:255], v[44:47], v[176:179]
    ds_write_b64 v30, v[38:39] offset:0
    v_mfma_f32_16x16x32_bf16 v[176:179], v[196:199], v[48:51], v[176:179]
    v_cvt_pk_bf16_f32 v40, v156, v157
    v_mfma_f32_16x16x32_bf16 v[176:179], v[208:211], v[52:55], v[176:179]
    v_mfma_f32_16x16x32_bf16 v[180:183], a[220:223], v[68:71], v[144:147]
    ds_read_b128 v[64:67], v37 offset:128
    v_mfma_f32_16x16x32_bf16 v[180:183], a[232:235], v[72:75], v[180:183]
    v_cvt_pk_bf16_f32 v41, v158, v159
    v_mfma_f32_16x16x32_bf16 v[180:183], a[244:247], v[76:79], v[180:183]
    ds_write_b64 v30, v[40:41] offset:8
    v_cvt_pk_bf16_f32 v42, v160, v161
    v_mfma_f32_16x16x32_bf16 v[180:183], v[188:191], v[44:47], v[180:183]
    v_cvt_pk_bf16_f32 v43, v162, v163
    ds_write_b64 v30, v[42:43] offset:16
    v_mfma_f32_16x16x32_bf16 v[180:183], v[200:203], v[48:51], v[180:183]
    v_cvt_pk_bf16_f32 v38, v164, v165
    v_cvt_pk_bf16_f32 v39, v166, v167
    v_mfma_f32_16x16x32_bf16 v[180:183], v[212:215], v[52:55], v[180:183]
    v_mfma_f32_16x16x32_bf16 v[184:187], a[224:227], v[68:71], v[148:151]
    ds_write_b64 v30, v[38:39] offset:416
    v_mfma_f32_16x16x32_bf16 v[184:187], a[236:239], v[72:75], v[184:187]
    v_cvt_pk_bf16_f32 v40, v168, v169
    v_mfma_f32_16x16x32_bf16 v[184:187], a[248:251], v[76:79], v[184:187]
    v_cvt_pk_bf16_f32 v41, v170, v171
    v_mfma_f32_16x16x32_bf16 v[184:187], v[192:195], v[44:47], v[184:187]
    ds_write_b64 v30, v[40:41] offset:424
    v_mfma_f32_16x16x32_bf16 v[184:187], v[204:207], v[48:51], v[184:187]
    v_cvt_pk_bf16_f32 v42, v172, v173
    v_mfma_f32_16x16x32_bf16 v[184:187], v[216:219], v[52:55], v[184:187]
    s_waitcnt lgkmcnt(7)
    v_mfma_f32_16x16x32_bf16 v[176:179], v[220:223], v[56:59], v[176:179]
    v_cvt_pk_bf16_f32 v43, v174, v175
    s_waitcnt lgkmcnt(6)
    v_mfma_f32_16x16x32_bf16 v[176:179], v[232:235], v[60:63], v[176:179]
    ds_write_b64 v30, v[42:43] offset:432
    s_waitcnt lgkmcnt(5)
    v_mfma_f32_16x16x32_bf16 v[176:179], v[244:247], v[64:67], v[176:179]
    v_mfma_f32_16x16x32_bf16 v[180:183], v[224:227], v[56:59], v[180:183]
    v_mfma_f32_16x16x32_bf16 v[180:183], v[236:239], v[60:63], v[180:183]
    v_mfma_f32_16x16x32_bf16 v[180:183], v[248:251], v[64:67], v[180:183]
    v_mfma_f32_16x16x32_bf16 v[184:187], v[228:231], v[56:59], v[184:187]
    v_mfma_f32_16x16x32_bf16 v[184:187], v[240:243], v[60:63], v[184:187]
    v_mfma_f32_16x16x32_bf16 v[184:187], v[252:255], v[64:67], v[184:187]
    s_nop 7
    s_nop 7
    v_cvt_pk_bf16_f32 v38, v176, v177
    v_cvt_pk_bf16_f32 v39, v178, v179
    ds_write_b64 v30, v[38:39] offset:832
    v_cvt_pk_bf16_f32 v40, v180, v181
    v_cvt_pk_bf16_f32 v41, v182, v183
    ds_write_b64 v30, v[40:41] offset:840
    v_cvt_pk_bf16_f32 v42, v184, v185
    v_cvt_pk_bf16_f32 v43, v186, v187
    ds_write_b64 v30, v[42:43] offset:848
    s_waitcnt lgkmcnt(0)
    s_barrier
    ds_read_b128 v[4:7], v31
    ds_read_b128 v[8:11], v32
    ds_read_b128 v[12:15], v33
    s_waitcnt lgkmcnt(2)
    buffer_store_dwordx4 v[4:7], v36, s[16:19], 0 offen offset:0 sc1
    ds_read_b128 v[4:7], v34
    s_waitcnt lgkmcnt(2)
    buffer_store_dwordx4 v[8:11], v36, s[16:19], 0 offen offset:1024 sc1
    ds_read_b128 v[8:11], v35
    s_waitcnt lgkmcnt(2)
    buffer_store_dwordx4 v[12:15], v36, s[16:19], 0 offen offset:2048 sc1
    s_waitcnt lgkmcnt(1)
    buffer_store_dwordx4 v[4:7], v36, s[16:19], 0 offen offset:3072 sc1
    s_waitcnt lgkmcnt(0)
    buffer_store_dwordx4 v[8:11], v36, s[84:87], 0 offen sc1
    v_add_u32 v36, 147456, v36
    s_mov_b32 s86, s88
    s_mov_b32 s18, 28311552
    s_waitcnt vmcnt(0)
L_end:
    s_endpgm
.section .rodata,"a"
.p2align 6
.amdhsa_kernel standalone__dilated_atrous__vision_kernel
  .amdhsa_next_free_vgpr 512
  .amdhsa_next_free_sgpr 100
  .amdhsa_accum_offset 256
  .amdhsa_group_segment_fixed_size 0
  .amdhsa_kernarg_size 40
  .amdhsa_user_sgpr_count 2
  .amdhsa_user_sgpr_kernarg_segment_ptr 1
  .amdhsa_system_sgpr_workgroup_id_x 1
.end_amdhsa_kernel
```
